```python
import torch

def _softmax(x, axis=-1):
    return torch.softmax(x, dim=axis)
def _gelu(x):
    return torch.nn.functional.gelu(x, approximate="tanh")
def _silu(x):
    return torch.nn.functional.silu(x)
def _sigmoid(x):
    return torch.sigmoid(x)
def _layernorm(x, axis=-1, eps=1e-5):
    m = x.mean(dim=axis, keepdim=True)
    v = x.var(dim=axis, keepdim=True, unbiased=False)
    return (x - m) / torch.sqrt(v + eps)
def _scatter_add(tgt, idx, src, axis=0):
    return tgt.clone().index_add_(axis, idx, src)
def _segment_sum(src, seg, n):
    out = torch.zeros((n,) + src.shape[1:], dtype=src.dtype)
    return out.index_add_(0, seg, src)
def _pad(x, pw):
    flat = tuple(v for pair in reversed(pw) for v in pair)
    return torch.nn.functional.pad(x, flat)

kernel_name = 'standalone__linear_kernel_rfa__prompt'

def setup_inputs():

    _w = (lambda a: (lambda t: t.to(torch.bfloat16) if t.is_floating_point() else t)(torch.as_tensor(a)))
    B, H, Sq, Sk, D, M = 1, 16, 2048, 2048, 256, 64
    return {
        "q": _w((lambda *s: torch.randn(*s, dtype=torch.bfloat16) * 0.05)(B, H, Sq, D)),
        "k": _w((lambda *s: torch.randn(*s, dtype=torch.bfloat16) * 0.8)(B, H, Sk, D)),
        "v": _w((lambda *s: torch.randn(*s, dtype=torch.bfloat16) * 0.8)(B, H, Sk, D)),
        "omega": _w((lambda *s: torch.randn(*s, dtype=torch.bfloat16) * 0.8)(M, D)),
    }

def reference(q, k, v, omega):
    d = q.shape[-1]
    m = omega.shape[0]
    scale = float(d) ** -0.25
    qs = q * scale
    ks = k * scale
    q_proj = torch.einsum("bhsd,md->bhsm", qs, omega)
    k_proj = torch.einsum("bhsd,md->bhsm", ks, omega)
    q_sq = 0.5 * torch.einsum("bhsd,bhsd->bhs", qs, qs)[..., None]
    k_sq = 0.5 * torch.einsum("bhsd,bhsd->bhs", ks, ks)[..., None]
    inv_sqrt_m = float(m) ** -0.5
    phi_q = torch.exp(q_proj - q_sq) * inv_sqrt_m + 1e-6
    phi_k = torch.exp(k_proj - k_sq) * inv_sqrt_m + 1e-6
    kv = torch.einsum("bhsm,bhsd->bhmd", phi_k, v)
    z  = torch.einsum("bhsm->bhm", phi_k)
    num = torch.einsum("bhqm,bhmd->bhqd", phi_q, kv)
    den = torch.einsum("bhqm,bhm->bhq", phi_q, z)[..., None] + 1e-6
    return num / den
```

```asm
; @launch grid=(256,1,1) block=(512,1,1) lds=163840
.amdgcn_target "amdgcn-amd-amdhsa--gfx950"
.text
.globl standalone__linear_kernel_rfa__prompt_kernel
.p2align 8
.type standalone__linear_kernel_rfa__prompt_kernel,@function
standalone__linear_kernel_rfa__prompt_kernel:
    s_cmp_ge_u32 s2, 256
    s_cbranch_scc1 L_end
    s_load_dwordx4 s[4:7], s[0:1], 0
    s_load_dwordx4 s[8:11], s[0:1], 16
    s_load_dwordx4 s[12:15], s[0:1], 32
    s_load_dwordx2 s[16:17], s[0:1], 48
    s_getpc_b64 s[100:101]
    v_and_b32 v1, 63, v0
    v_lshlrev_b32 v1, 7, v1
    global_load_dword v32, v1, s[100:101]
    v_add_u32 v1, 8192, v1
    v_min_u32 v1, 11648, v1
    global_load_dword v33, v1, s[100:101]
    v_lshrrev_b32 v1, 6, v0
    v_and_b32 v0, 63, v0
    v_readfirstlane_b32 s56, v1
    s_and_b32 s58, s2, 7
    s_lshr_b32 s59, s2, 3
    s_lshr_b32 s18, s59, 4
    s_lshl_b32 s58, s58, 1
    s_add_u32 s18, s18, s58
    s_and_b32 s19, s59, 15
    s_and_b32 s57, s56, 3
    v_lshrrev_b32 v12, 5, v0
    v_and_b32 v13, 31, v0
    v_xor_b32 v13, v13, v12
    v_lshlrev_b32 v13, 4, v13
    v_lshl_add_u32 v10, v12, 9, v13
    v_lshlrev_b32 v11, 4, v0
    s_lshl_b32 s58, s18, 20
    s_lshl_b32 s59, s19, 16
    s_add_u32 s58, s58, s59
    s_waitcnt lgkmcnt(0)
    s_mov_b32 s32, s10
    s_and_b32 s33, s11, 0xffff
    s_mov_b32 s34, 32768
    s_mov_b32 s35, 0x20000
    s_add_u32 s20, s6, s58
    s_addc_u32 s21, s7, 0
    s_and_b32 s21, s21, 0xffff
    s_mov_b32 s22, 65536
    s_mov_b32 s23, 0x20000
    s_lshl_b32 s71, s56, 13
    s_add_u32 m0, s71, 0
    s_nop 0
    buffer_load_dwordx4 v10, s[20:23], s71 offen offset:0 nt lds
    v_xor_b32 v12, 32, v10
    buffer_load_dwordx4 v12, s[20:23], s71 offen offset:1024 nt lds
    v_xor_b32 v12, 64, v10
    buffer_load_dwordx4 v12, s[20:23], s71 offen offset:2048 nt lds
    v_xor_b32 v12, 96, v10
    buffer_load_dwordx4 v12, s[20:23], s71 offen offset:3072 nt lds
    s_mov_b32 s61, s71
    s_and_b32 s59, s56, 1
    s_lshl_b32 s59, s59, 7
    s_lshl_b32 s71, s56, 12
    s_add_u32 m0, s71, 131072
    s_add_u32 s60, s59, 0
    v_xor_b32 v12, s60, v10
    buffer_load_dwordx4 v12, s[32:35], s71 offen offset:0 lds
    s_add_u32 s60, s59, 32
    v_xor_b32 v12, s60, v10
    buffer_load_dwordx4 v12, s[32:35], s71 offen offset:1024 lds
    s_add_u32 s60, s59, 64
    v_xor_b32 v12, s60, v10
    buffer_load_dwordx4 v12, s[32:35], s71 offen offset:2048 lds
    s_add_u32 s60, s59, 96
    v_xor_b32 v12, s60, v10
    buffer_load_dwordx4 v12, s[32:35], s71 offen offset:3072 lds
    s_mov_b32 s71, s61
    s_barrier
    s_add_u32 s71, s71, 4096
    s_add_u32 m0, s71, 0
    v_xor_b32 v12, 128, v10
    buffer_load_dwordx4 v12, s[20:23], s71 offen offset:0 nt lds
    v_xor_b32 v12, 160, v10
    buffer_load_dwordx4 v12, s[20:23], s71 offen offset:1024 nt lds
    v_xor_b32 v12, 192, v10
    buffer_load_dwordx4 v12, s[20:23], s71 offen offset:2048 nt lds
    v_xor_b32 v12, 224, v10
    buffer_load_dwordx4 v12, s[20:23], s71 offen offset:3072 nt lds
    s_add_u32 s24, s8, s58
    s_addc_u32 s25, s9, 0
    s_and_b32 s25, s25, 0xffff
    s_mov_b32 s26, 65536
    s_mov_b32 s27, 0x20000
    v_lshrrev_b32 v30, 4, v0
    v_and_b32 v30, 1, v30
    v_lshlrev_b32 v30, 2, v30
    v_and_b32 v13, 7, v0
    v_xor_b32 v30, v30, v13
    v_lshlrev_b32 v30, 4, v30
    v_lshrrev_b32 v13, 3, v0
    v_lshl_add_u32 v30, v13, 9, v30
    s_lshr_b32 s61, s56, 2
    s_lshl_b32 s61, s61, 2
    s_lshl_b32 s71, s61, 12
    s_lshl_b32 s59, s57, 7
    s_add_u32 s71, s71, s59
    s_lshl_b32 s59, s61, 10
    s_lshl_b32 s60, s57, 14
    s_add_u32 s59, s59, s60
    s_add_u32 s59, s59, 65536
    s_add_u32 m0, s59, 0
    s_nop 0
    buffer_load_dwordx4 v30, s[24:27], s71 offen nt lds
    s_add_u32 m0, s59, 1024
    s_add_u32 s71, s71, 4096
    buffer_load_dwordx4 v30, s[24:27], s71 offen nt lds
    s_add_u32 m0, s59, 2048
    s_add_u32 s71, s71, 4096
    buffer_load_dwordx4 v30, s[24:27], s71 offen nt lds
    s_add_u32 m0, s59, 3072
    s_add_u32 s71, s71, 4096
    buffer_load_dwordx4 v30, s[24:27], s71 offen nt lds
    s_lshl_b32 s59, s18, 20
    s_add_u32 s96, s16, s59
    s_addc_u32 s97, s17, 0
    s_load_dword s62, s[96:97], 561152
    s_load_dword s47, s[96:97], 561408
    s_load_dword s47, s[96:97], 561472
    s_load_dword s47, s[96:97], 561536
    s_load_dword s47, s[96:97], 561600
    s_load_dword s47, s[96:97], 561664
    s_load_dword s47, s[96:97], 561728
    s_load_dword s47, s[96:97], 561792
    s_load_dword s47, s[96:97], 561856
    s_add_u32 s28, s4, s58
    s_addc_u32 s29, s5, 0
    s_and_b32 s29, s29, 0xffff
    s_mov_b32 s30, 65536
    s_mov_b32 s31, 0x20000
    s_add_u32 s36, s12, s58
    s_addc_u32 s37, s13, 0
    s_and_b32 s37, s37, 0xffff
    s_mov_b32 s38, 65536
    s_mov_b32 s39, 0x20000
    s_load_dword s44, s[28:29], 0
    s_load_dword s45, s[36:37], 0
    s_load_dword s46, s[24:25], 0
    v_and_b32 v12, 31, v0
    v_lshrrev_b32 v13, 5, v0
    v_and_b32 v14, 15, v0
    v_xor_b32 v14, v14, v13
    v_lshlrev_b32 v14, 4, v14
    v_lshl_add_u32 v14, v12, 9, v14
    v_add_u32 v2, 131072, v14
    v_xor_b32 v3, 32, v2
    v_xor_b32 v4, 64, v2
    v_xor_b32 v5, 96, v2
    v_xor_b32 v6, 128, v2
    v_xor_b32 v7, 160, v2
    v_xor_b32 v8, 192, v2
    v_xor_b32 v9, 224, v2
    s_mov_b32 s64, 0x00003e80
    s_mov_b32 s65, 0x3e800000
    s_mov_b32 s66, 0x3fb8aa3b
    s_mov_b32 s67, 0x3e000000
    s_mov_b32 s68, 0xffff0000
    s_mov_b32 s69, 0x3f803f80
    s_mov_b32 s72, 0x358637bd
    s_mov_b32 s73, 0xbd000000
    s_waitcnt lgkmcnt(0)
    s_add_u32 s62, s62, 1
    s_lshl_b32 s59, s18, 20
    s_add_u32 s40, s16, s59
    s_addc_u32 s41, s17, 0
    s_and_b32 s41, s41, 0xffff
    s_mov_b32 s42, 1048576
    s_mov_b32 s43, 0x20000
    s_mov_b32 s63, 0
    s_getreg_b32 s94, hwreg(HW_REG_XCC_ID, 0, 4)
    s_lshl_b32 s95, s62, 4
    s_add_u32 s95, s95, s94
    s_cmp_eq_u32 s56, 0
    s_cbranch_scc0 L_nopres
    s_mov_b64 exec, 1
    s_lshl_b32 s59, s19, 2
    s_add_u32 s59, s59, 561280
    v_mov_b32 v12, 0
    v_mov_b32 v13, s95
    buffer_store_dword v13, v12, s[40:43], s59 offen sc1
    s_mov_b64 exec, -1
    s_waitcnt vmcnt(9)
    s_branch L_presd
L_nopres:
    s_waitcnt vmcnt(8)
L_presd:
    s_barrier
    s_cmp_ge_u32 s56, 4
    s_cbranch_scc1 L_team_b
    ds_read_b128 v[128:131], v2 offset:0
    ds_read_b128 v[192:195], v2 offset:16384
    ds_read_b128 v[132:135], v3 offset:0
    ds_read_b128 v[196:199], v3 offset:16384
    ds_read_b128 v[136:139], v4 offset:0
    ds_read_b128 v[200:203], v4 offset:16384
    ds_read_b128 v[140:143], v5 offset:0
    ds_read_b128 v[204:207], v5 offset:16384
    ds_read_b128 v[144:147], v6 offset:0
    ds_read_b128 v[208:211], v6 offset:16384
    ds_read_b128 v[148:151], v7 offset:0
    ds_read_b128 v[212:215], v7 offset:16384
    ds_read_b128 v[152:155], v8 offset:0
    ds_read_b128 v[216:219], v8 offset:16384
    ds_read_b128 v[156:159], v9 offset:0
    ds_read_b128 v[220:223], v9 offset:16384
    ds_read_b128 v[160:163], v2 offset:256
    ds_read_b128 v[224:227], v2 offset:16640
    ds_read_b128 v[164:167], v3 offset:256
    ds_read_b128 v[228:231], v3 offset:16640
    ds_read_b128 v[168:171], v4 offset:256
    ds_read_b128 v[232:235], v4 offset:16640
    ds_read_b128 v[172:175], v5 offset:256
    ds_read_b128 v[236:239], v5 offset:16640
    ds_read_b128 v[176:179], v6 offset:256
    ds_read_b128 v[240:243], v6 offset:16640
    ds_read_b128 v[180:183], v7 offset:256
    ds_read_b128 v[244:247], v7 offset:16640
    ds_read_b128 v[184:187], v8 offset:256
    ds_read_b128 v[248:251], v8 offset:16640
    ds_read_b128 v[188:191], v9 offset:256
    ds_read_b128 v[252:255], v9 offset:16640
    s_lshl_b32 s59, s57, 14
    s_sub_u32 s59, s59, 131072
    v_add_u32 v2, s59, v2
    v_add_u32 v3, s59, v3
    v_add_u32 v4, s59, v4
    v_add_u32 v5, s59, v5
    v_add_u32 v6, s59, v6
    v_add_u32 v7, s59, v7
    v_add_u32 v8, s59, v8
    v_add_u32 v9, s59, v9
    s_waitcnt vmcnt(5) lgkmcnt(0)
    s_cmp_eq_u32 s57, 0
    s_cbranch_scc1 L_k0
    s_waitcnt vmcnt(4)
L_k0:
    s_barrier
    ds_read_b128 v[32:35], v2 offset:0
    ds_read_b128 v[36:39], v3 offset:0
    ds_read_b128 v[40:43], v4 offset:0
    ds_read_b128 v[44:47], v5 offset:0
    ds_read_b128 v[48:51], v6 offset:0
    ds_read_b128 v[52:55], v7 offset:0
    ds_read_b128 v[56:59], v8 offset:0
    ds_read_b128 v[60:63], v9 offset:0
    ds_read_b128 v[64:67], v2 offset:256
    ds_read_b128 v[68:71], v3 offset:256
    ds_read_b128 v[72:75], v4 offset:256
    ds_read_b128 v[76:79], v5 offset:256
    ds_read_b128 v[80:83], v6 offset:256
    ds_read_b128 v[84:87], v7 offset:256
    ds_read_b128 v[88:91], v8 offset:256
    ds_read_b128 v[92:95], v9 offset:256
    v_mov_b32 v28, 0
    v_mov_b32 v29, 0
    v_mov_b32 v30, 0
    v_mov_b32 v31, 0
    s_waitcnt lgkmcnt(0)
    s_barrier
    v_dot2c_f32_bf16 v28, v32, v32
    v_dot2c_f32_bf16 v29, v33, v33
    v_dot2c_f32_bf16 v30, v34, v34
    v_dot2c_f32_bf16 v31, v35, v35
    v_dot2c_f32_bf16 v28, v36, v36
    v_dot2c_f32_bf16 v29, v37, v37
    v_dot2c_f32_bf16 v30, v38, v38
    v_dot2c_f32_bf16 v31, v39, v39
    v_dot2c_f32_bf16 v28, v40, v40
    v_dot2c_f32_bf16 v29, v41, v41
    v_dot2c_f32_bf16 v30, v42, v42
    v_dot2c_f32_bf16 v31, v43, v43
    v_dot2c_f32_bf16 v28, v44, v44
    v_dot2c_f32_bf16 v29, v45, v45
    v_dot2c_f32_bf16 v30, v46, v46
    v_dot2c_f32_bf16 v31, v47, v47
    v_dot2c_f32_bf16 v28, v48, v48
    v_dot2c_f32_bf16 v29, v49, v49
    v_dot2c_f32_bf16 v30, v50, v50
    v_dot2c_f32_bf16 v31, v51, v51
    v_dot2c_f32_bf16 v28, v52, v52
    v_dot2c_f32_bf16 v29, v53, v53
    v_dot2c_f32_bf16 v30, v54, v54
    v_dot2c_f32_bf16 v31, v55, v55
    v_dot2c_f32_bf16 v28, v56, v56
    v_dot2c_f32_bf16 v29, v57, v57
    v_dot2c_f32_bf16 v30, v58, v58
    v_dot2c_f32_bf16 v31, v59, v59
    v_dot2c_f32_bf16 v28, v60, v60
    v_dot2c_f32_bf16 v29, v61, v61
    v_dot2c_f32_bf16 v30, v62, v62
    v_dot2c_f32_bf16 v31, v63, v63
    v_dot2c_f32_bf16 v28, v64, v64
    v_dot2c_f32_bf16 v29, v65, v65
    v_dot2c_f32_bf16 v30, v66, v66
    v_dot2c_f32_bf16 v31, v67, v67
    v_dot2c_f32_bf16 v28, v68, v68
    v_dot2c_f32_bf16 v29, v69, v69
    v_dot2c_f32_bf16 v30, v70, v70
    v_dot2c_f32_bf16 v31, v71, v71
    v_dot2c_f32_bf16 v28, v72, v72
    v_dot2c_f32_bf16 v29, v73, v73
    v_dot2c_f32_bf16 v30, v74, v74
    v_dot2c_f32_bf16 v31, v75, v75
    v_dot2c_f32_bf16 v28, v76, v76
    v_dot2c_f32_bf16 v29, v77, v77
    v_dot2c_f32_bf16 v30, v78, v78
    v_dot2c_f32_bf16 v31, v79, v79
    v_dot2c_f32_bf16 v28, v80, v80
    v_dot2c_f32_bf16 v29, v81, v81
    v_dot2c_f32_bf16 v30, v82, v82
    v_dot2c_f32_bf16 v31, v83, v83
    v_dot2c_f32_bf16 v28, v84, v84
    v_dot2c_f32_bf16 v29, v85, v85
    v_dot2c_f32_bf16 v30, v86, v86
    v_dot2c_f32_bf16 v31, v87, v87
    v_dot2c_f32_bf16 v28, v88, v88
    v_dot2c_f32_bf16 v29, v89, v89
    v_dot2c_f32_bf16 v30, v90, v90
    v_dot2c_f32_bf16 v31, v91, v91
    v_dot2c_f32_bf16 v28, v92, v92
    v_dot2c_f32_bf16 v29, v93, v93
    v_dot2c_f32_bf16 v30, v94, v94
    v_dot2c_f32_bf16 v31, v95, v95
    v_mfma_f32_32x32x16_bf16 v[96:111], v[32:35], v[128:131], 0
    v_mfma_f32_32x32x16_bf16 v[96:111], v[36:39], v[132:135], v[96:111]
    v_add_f32 v28, v28, v29
    v_add_f32 v30, v30, v31
    v_mfma_f32_32x32x16_bf16 v[96:111], v[40:43], v[136:139], v[96:111]
    v_add_f32 v28, v28, v30
    v_mfma_f32_32x32x16_bf16 v[96:111], v[44:47], v[140:143], v[96:111]
    v_mov_b32 v29, v28
    v_mfma_f32_32x32x16_bf16 v[96:111], v[48:51], v[144:147], v[96:111]
    s_nop 0
    v_permlane32_swap_b32 v28, v29
    v_mfma_f32_32x32x16_bf16 v[96:111], v[52:55], v[148:151], v[96:111]
    v_add_f32 v28, v28, v29
    v_mfma_f32_32x32x16_bf16 v[96:111], v[56:59], v[152:155], v[96:111]
    v_mul_f32 v28, s73, v28
    v_lshrrev_b32 v29, 5, v0
    v_mfma_f32_32x32x16_bf16 v[96:111], v[60:63], v[156:159], v[96:111]
    v_cmp_eq_u32 vcc, 0, v29
    v_mfma_f32_32x32x16_bf16 v[96:111], v[64:67], v[160:163], v[96:111]
    s_nop 0
    v_cndmask_b32 v28, 0, v28, vcc
    v_mfma_f32_32x32x16_bf16 v[96:111], v[68:71], v[164:167], v[96:111]
    v_cvt_pk_bf16_f32 v28, v28, 0
    v_mfma_f32_32x32x16_bf16 v[96:111], v[72:75], v[168:171], v[96:111]
    s_mov_b32 s61, 0x3e800000
    v_mfma_f32_32x32x16_bf16 v[96:111], v[76:79], v[172:175], v[96:111]
    v_mfma_f32_32x32x16_bf16 v[96:111], v[80:83], v[176:179], v[96:111]
    v_mov_b32 v144, v28
    v_mov_b32 v148, 0x3f80
    v_mfma_f32_32x32x16_bf16 v[96:111], v[84:87], v[180:183], v[96:111]
    v_mov_b32 v149, 0
    v_mov_b32 v145, 0
    v_mov_b32 v150, 0
    v_mov_b32 v146, 0
    v_mov_b32 v151, 0
    v_mov_b32 v147, 0
    v_mfma_f32_32x32x16_bf16 v[96:111], v[88:91], v[184:187], v[96:111]
    v_mfma_f32_32x32x16_bf16 v[96:111], v[92:95], v[188:191], v[96:111]
    v_mfma_f32_32x32x16_bf16 v[128:143], v[144:147], v[148:151], 0
    v_mfma_f32_32x32x16_bf16 v[112:127], v[32:35], v[192:195], 0
    v_mfma_f32_32x32x16_bf16 v[112:127], v[36:39], v[196:199], v[112:127]
    v_mov_b32 v164, s72
    s_nop 7
    v_cvt_pk_bf16_f32 v152, v96, v97
    v_cvt_pk_bf16_f32 v153, v98, v99
    v_cvt_pk_bf16_f32 v154, v100, v101
    v_cvt_pk_bf16_f32 v155, v102, v103
    v_mfma_f32_32x32x16_bf16 v[112:127], v[40:43], v[200:203], v[112:127]
    v_lshlrev_b32 v156, 16, v152
    v_and_b32 v157, s68, v152
    v_lshlrev_b32 v158, 16, v153
    v_and_b32 v159, s68, v153
    v_lshlrev_b32 v160, 16, v154
    v_mfma_f32_32x32x16_bf16 v[112:127], v[44:47], v[204:207], v[112:127]
    v_and_b32 v161, s68, v154
    v_lshlrev_b32 v162, 16, v155
    v_and_b32 v163, s68, v155
    v_fma_f32 v156, v156, s61, v128
    v_fma_f32 v157, v157, s61, v129
    v_mfma_f32_32x32x16_bf16 v[112:127], v[48:51], v[208:211], v[112:127]
    v_fma_f32 v158, v158, s61, v130
    v_fma_f32 v159, v159, s61, v131
    v_fma_f32 v160, v160, s61, v132
    v_fma_f32 v161, v161, s61, v133
    v_fma_f32 v162, v162, s61, v134
    v_mfma_f32_32x32x16_bf16 v[112:127], v[52:55], v[212:215], v[112:127]
    v_fma_f32 v163, v163, s61, v135
    v_cvt_pk_bf16_f32 v152, v156, v157
    v_cvt_pk_bf16_f32 v153, v158, v159
    v_cvt_pk_bf16_f32 v154, v160, v161
    v_cvt_pk_bf16_f32 v155, v162, v163
    v_mfma_f32_32x32x16_bf16 v[112:127], v[56:59], v[216:219], v[112:127]
    v_lshlrev_b32 v156, 16, v152
    v_and_b32 v157, s68, v152
    v_lshlrev_b32 v158, 16, v153
    v_and_b32 v159, s68, v153
    v_lshlrev_b32 v160, 16, v154
    v_mfma_f32_32x32x16_bf16 v[112:127], v[60:63], v[220:223], v[112:127]
    v_and_b32 v161, s68, v154
    v_lshlrev_b32 v162, 16, v155
    v_and_b32 v163, s68, v155
    v_mul_f32 v156, s66, v156
    v_mul_f32 v157, s66, v157
    v_mfma_f32_32x32x16_bf16 v[112:127], v[64:67], v[224:227], v[112:127]
    v_mul_f32 v158, s66, v158
    v_mul_f32 v159, s66, v159
    v_mul_f32 v160, s66, v160
    v_mul_f32 v161, s66, v161
    v_mul_f32 v162, s66, v162
    v_mfma_f32_32x32x16_bf16 v[112:127], v[68:71], v[228:231], v[112:127]
    v_mul_f32 v163, s66, v163
    v_exp_f32 v156, v156
    v_exp_f32 v157, v157
    v_exp_f32 v158, v158
    v_exp_f32 v159, v159
    v_mfma_f32_32x32x16_bf16 v[112:127], v[72:75], v[232:235], v[112:127]
    v_exp_f32 v160, v160
    v_exp_f32 v161, v161
    v_exp_f32 v162, v162
    v_exp_f32 v163, v163
    v_fma_f32 v156, v156, s67, v164
    v_mfma_f32_32x32x16_bf16 v[112:127], v[76:79], v[236:239], v[112:127]
    v_fma_f32 v157, v157, s67, v164
    v_fma_f32 v158, v158, s67, v164
    v_fma_f32 v159, v159, s67, v164
    v_fma_f32 v160, v160, s67, v164
    v_fma_f32 v161, v161, s67, v164
    v_mfma_f32_32x32x16_bf16 v[112:127], v[80:83], v[240:243], v[112:127]
    v_fma_f32 v162, v162, s67, v164
    v_fma_f32 v163, v163, s67, v164
    v_cvt_pk_bf16_f32 v12, v156, v157
    v_cvt_pk_bf16_f32 v13, v158, v159
    v_cvt_pk_bf16_f32 v14, v160, v161
    v_mfma_f32_32x32x16_bf16 v[112:127], v[84:87], v[244:247], v[112:127]
    v_cvt_pk_bf16_f32 v15, v162, v163
    v_cvt_pk_bf16_f32 v152, v104, v105
    v_cvt_pk_bf16_f32 v153, v106, v107
    v_cvt_pk_bf16_f32 v154, v108, v109
    v_cvt_pk_bf16_f32 v155, v110, v111
    v_mfma_f32_32x32x16_bf16 v[112:127], v[88:91], v[248:251], v[112:127]
    v_lshlrev_b32 v156, 16, v152
    v_and_b32 v157, s68, v152
    v_lshlrev_b32 v158, 16, v153
    v_and_b32 v159, s68, v153
    v_lshlrev_b32 v160, 16, v154
    v_mfma_f32_32x32x16_bf16 v[112:127], v[92:95], v[252:255], v[112:127]
    v_and_b32 v161, s68, v154
    v_lshlrev_b32 v162, 16, v155
    v_and_b32 v163, s68, v155
    v_fma_f32 v156, v156, s61, v136
    v_fma_f32 v157, v157, s61, v137
    v_fma_f32 v158, v158, s61, v138
    v_fma_f32 v159, v159, s61, v139
    v_fma_f32 v160, v160, s61, v140
    v_fma_f32 v161, v161, s61, v141
    v_fma_f32 v162, v162, s61, v142
    v_fma_f32 v163, v163, s61, v143
    v_cvt_pk_bf16_f32 v152, v156, v157
    v_cvt_pk_bf16_f32 v153, v158, v159
    v_cvt_pk_bf16_f32 v154, v160, v161
    v_cvt_pk_bf16_f32 v155, v162, v163
    v_lshlrev_b32 v156, 16, v152
    v_and_b32 v157, s68, v152
    v_lshlrev_b32 v158, 16, v153
    v_and_b32 v159, s68, v153
    v_lshlrev_b32 v160, 16, v154
    v_and_b32 v161, s68, v154
    v_lshlrev_b32 v162, 16, v155
    v_and_b32 v163, s68, v155
    v_mul_f32 v156, s66, v156
    v_mul_f32 v157, s66, v157
    v_mul_f32 v158, s66, v158
    v_mul_f32 v159, s66, v159
    v_mul_f32 v160, s66, v160
    v_mul_f32 v161, s66, v161
    v_mul_f32 v162, s66, v162
    v_mul_f32 v163, s66, v163
    v_exp_f32 v156, v156
    v_exp_f32 v157, v157
    v_exp_f32 v158, v158
    v_exp_f32 v159, v159
    v_exp_f32 v160, v160
    v_exp_f32 v161, v161
    v_exp_f32 v162, v162
    v_exp_f32 v163, v163
    v_fma_f32 v156, v156, s67, v164
    v_fma_f32 v157, v157, s67, v164
    v_fma_f32 v158, v158, s67, v164
    v_fma_f32 v159, v159, s67, v164
    v_fma_f32 v160, v160, s67, v164
    v_fma_f32 v161, v161, s67, v164
    v_fma_f32 v162, v162, s67, v164
    v_fma_f32 v163, v163, s67, v164
    v_cvt_pk_bf16_f32 v16, v156, v157
    v_cvt_pk_bf16_f32 v17, v158, v159
    v_cvt_pk_bf16_f32 v18, v160, v161
    v_cvt_pk_bf16_f32 v19, v162, v163
    v_lshl_add_u32 v72, s57, 12, v11
    v_add_u32 v72, 131072, v72
    ds_write_b128 v72, v[12:15] offset:0
    ds_write_b128 v72, v[16:19] offset:2048
    v_cvt_pk_bf16_f32 v152, v112, v113
    v_cvt_pk_bf16_f32 v153, v114, v115
    v_cvt_pk_bf16_f32 v154, v116, v117
    v_cvt_pk_bf16_f32 v155, v118, v119
    v_lshlrev_b32 v156, 16, v152
    v_and_b32 v157, s68, v152
    v_lshlrev_b32 v158, 16, v153
    v_and_b32 v159, s68, v153
    v_lshlrev_b32 v160, 16, v154
    v_and_b32 v161, s68, v154
    v_lshlrev_b32 v162, 16, v155
    v_and_b32 v163, s68, v155
    v_fma_f32 v156, v156, s61, v128
    v_fma_f32 v157, v157, s61, v129
    v_fma_f32 v158, v158, s61, v130
    v_fma_f32 v159, v159, s61, v131
    v_fma_f32 v160, v160, s61, v132
    v_fma_f32 v161, v161, s61, v133
    v_fma_f32 v162, v162, s61, v134
    v_fma_f32 v163, v163, s61, v135
    v_cvt_pk_bf16_f32 v152, v156, v157
    v_cvt_pk_bf16_f32 v153, v158, v159
    v_cvt_pk_bf16_f32 v154, v160, v161
    v_cvt_pk_bf16_f32 v155, v162, v163
    v_lshlrev_b32 v156, 16, v152
    v_and_b32 v157, s68, v152
    v_lshlrev_b32 v158, 16, v153
    v_and_b32 v159, s68, v153
    v_lshlrev_b32 v160, 16, v154
    v_and_b32 v161, s68, v154
    v_lshlrev_b32 v162, 16, v155
    v_and_b32 v163, s68, v155
    v_mul_f32 v156, s66, v156
    v_mul_f32 v157, s66, v157
    v_mul_f32 v158, s66, v158
    v_mul_f32 v159, s66, v159
    v_mul_f32 v160, s66, v160
    v_mul_f32 v161, s66, v161
    v_mul_f32 v162, s66, v162
    v_mul_f32 v163, s66, v163
    v_exp_f32 v156, v156
    v_exp_f32 v157, v157
    v_exp_f32 v158, v158
    v_exp_f32 v159, v159
    v_exp_f32 v160, v160
    v_exp_f32 v161, v161
    v_exp_f32 v162, v162
    v_exp_f32 v163, v163
    v_fma_f32 v156, v156, s67, v164
    v_fma_f32 v157, v157, s67, v164
    v_fma_f32 v158, v158, s67, v164
    v_fma_f32 v159, v159, s67, v164
    v_fma_f32 v160, v160, s67, v164
    v_fma_f32 v161, v161, s67, v164
    v_fma_f32 v162, v162, s67, v164
    v_fma_f32 v163, v163, s67, v164
    v_cvt_pk_bf16_f32 v20, v156, v157
    v_cvt_pk_bf16_f32 v21, v158, v159
    v_cvt_pk_bf16_f32 v22, v160, v161
    v_cvt_pk_bf16_f32 v23, v162, v163
    v_cvt_pk_bf16_f32 v152, v120, v121
    v_cvt_pk_bf16_f32 v153, v122, v123
    v_cvt_pk_bf16_f32 v154, v124, v125
    v_cvt_pk_bf16_f32 v155, v126, v127
    v_lshlrev_b32 v156, 16, v152
    v_and_b32 v157, s68, v152
    v_lshlrev_b32 v158, 16, v153
    v_and_b32 v159, s68, v153
    v_lshlrev_b32 v160, 16, v154
    v_and_b32 v161, s68, v154
    v_lshlrev_b32 v162, 16, v155
    v_and_b32 v163, s68, v155
    v_fma_f32 v156, v156, s61, v136
    v_fma_f32 v157, v157, s61, v137
    v_fma_f32 v158, v158, s61, v138
    v_fma_f32 v159, v159, s61, v139
    v_fma_f32 v160, v160, s61, v140
    v_fma_f32 v161, v161, s61, v141
    v_fma_f32 v162, v162, s61, v142
    v_fma_f32 v163, v163, s61, v143
    v_cvt_pk_bf16_f32 v152, v156, v157
    v_cvt_pk_bf16_f32 v153, v158, v159
    v_cvt_pk_bf16_f32 v154, v160, v161
    v_cvt_pk_bf16_f32 v155, v162, v163
    v_lshlrev_b32 v156, 16, v152
    v_and_b32 v157, s68, v152
    v_lshlrev_b32 v158, 16, v153
    v_and_b32 v159, s68, v153
    v_lshlrev_b32 v160, 16, v154
    v_and_b32 v161, s68, v154
    v_lshlrev_b32 v162, 16, v155
    v_and_b32 v163, s68, v155
    v_mul_f32 v156, s66, v156
    v_mul_f32 v157, s66, v157
    v_mul_f32 v158, s66, v158
    v_mul_f32 v159, s66, v159
    v_mul_f32 v160, s66, v160
    v_mul_f32 v161, s66, v161
    v_mul_f32 v162, s66, v162
    v_mul_f32 v163, s66, v163
    v_exp_f32 v156, v156
    v_exp_f32 v157, v157
    v_exp_f32 v158, v158
    v_exp_f32 v159, v159
    v_exp_f32 v160, v160
    v_exp_f32 v161, v161
    v_exp_f32 v162, v162
    v_exp_f32 v163, v163
    v_fma_f32 v156, v156, s67, v164
    v_fma_f32 v157, v157, s67, v164
    v_fma_f32 v158, v158, s67, v164
    v_fma_f32 v159, v159, s67, v164
    v_fma_f32 v160, v160, s67, v164
    v_fma_f32 v161, v161, s67, v164
    v_fma_f32 v162, v162, s67, v164
    v_fma_f32 v163, v163, s67, v164
    v_cvt_pk_bf16_f32 v24, v156, v157
    v_cvt_pk_bf16_f32 v25, v158, v159
    v_cvt_pk_bf16_f32 v26, v160, v161
    v_cvt_pk_bf16_f32 v27, v162, v163
    ds_write_b128 v72, v[20:23] offset:1024
    ds_write_b128 v72, v[24:27] offset:3072
    v_mov_b32 v69, 0
    v_mov_b32 v70, 0
    v_dot2c_f32_bf16 v69, s69, v12
    v_dot2c_f32_bf16 v70, s69, v20
    v_dot2c_f32_bf16 v69, s69, v13
    v_dot2c_f32_bf16 v70, s69, v21
    v_dot2c_f32_bf16 v69, s69, v14
    v_dot2c_f32_bf16 v70, s69, v22
    v_dot2c_f32_bf16 v69, s69, v15
    v_dot2c_f32_bf16 v70, s69, v23
    v_dot2c_f32_bf16 v69, s69, v16
    v_dot2c_f32_bf16 v70, s69, v24
    v_dot2c_f32_bf16 v69, s69, v17
    v_dot2c_f32_bf16 v70, s69, v25
    v_dot2c_f32_bf16 v69, s69, v18
    v_dot2c_f32_bf16 v70, s69, v26
    v_dot2c_f32_bf16 v69, s69, v19
    v_dot2c_f32_bf16 v70, s69, v27
    s_nop 1
    v_mov_b32 v73, v69
    v_mov_b32 v74, v70
    s_nop 0
    v_permlane32_swap_b32 v69, v73
    v_permlane32_swap_b32 v70, v74
    v_add_f32 v69, v69, v73
    v_add_f32 v70, v70, v74
    v_and_b32 v73, 31, v0
    v_lshlrev_b32 v73, 2, v73
    s_lshl_b32 s59, s57, 8
    s_add_u32 s59, s59, 147456
    v_add_u32 v73, s59, v73
    ds_write_b32 v73, v69
    ds_write_b32 v73, v70 offset:128
    s_waitcnt lgkmcnt(0)
    s_lshl_b32 s60, s57, 2
    s_add_u32 s60, s60, 148736
    v_mov_b32 v76, s60
    v_mov_b32 v77, s62
    ds_write_b32 v76, v77
    v_lshrrev_b32 v12, 5, v0
    v_lshlrev_b32 v12, 2, v12
    v_bfe_u32 v13, v0, 2, 2
    v_add_u32 v12, v12, v13
    v_lshlrev_b32 v12, 7, v12
    v_lshrrev_b32 v13, 1, v13
    v_lshl_add_u32 v12, v13, 6, v12
    v_bfe_u32 v13, v0, 4, 1
    v_lshl_add_u32 v12, v13, 5, v12
    v_and_b32 v13, 3, v0
    v_lshl_add_u32 v12, v13, 3, v12
    s_lshl_b32 s59, s57, 14
    s_add_u32 s59, s59, 65536
    v_add_u32 v28, s59, v12
    v_xor_b32 v29, 64, v28
    v_add_u32 v30, 131072, v11
    s_mov_b32 s70, 0
    v_and_b32 v76, 3, v0
    v_lshlrev_b32 v76, 2, v76
    v_add_u32 v76, 148736, v76
    s_nop 1
L_ls_phi:
    ds_read_b32 v77, v76
    s_waitcnt lgkmcnt(0)
    v_cmp_ne_u32 vcc, s62, v77
    s_nop 4
    s_cbranch_vccz L_lsd_phi
    s_add_u32 s70, s70, 1
    s_cmp_lt_u32 s70, 480000
    s_cbranch_scc1 L_ls_phi
L_lsd_phi:
    ds_read_b128 v[128:131], v30 offset:0
    ds_read_b128 v[132:135], v30 offset:1024
    ds_read_b128 v[136:139], v30 offset:2048
    ds_read_b128 v[140:143], v30 offset:3072
    ds_read_b128 v[144:147], v30 offset:4096
    ds_read_b128 v[148:151], v30 offset:5120
    ds_read_b128 v[152:155], v30 offset:6144
    ds_read_b128 v[156:159], v30 offset:7168
    ds_read_b128 v[160:163], v30 offset:8192
    ds_read_b128 v[164:167], v30 offset:9216
    ds_read_b128 v[168:171], v30 offset:10240
    ds_read_b128 v[172:175], v30 offset:11264
    ds_read_b128 v[176:179], v30 offset:12288
    ds_read_b128 v[180:183], v30 offset:13312
    ds_read_b128 v[184:187], v30 offset:14336
    ds_read_b128 v[188:191], v30 offset:15360
    s_lshl_b32 s60, s57, 2
    s_add_u32 s60, s60, 148752
    s_waitcnt vmcnt(0)
    s_mov_b32 s70, 0
    v_mov_b32 v26, s60
    s_nop 1
L_ls_v1:
    ds_read_b32 v27, v26
    s_waitcnt lgkmcnt(0)
    v_cmp_ne_u32 vcc, s62, v27
    s_nop 4
    s_cbranch_vccz L_lsd_v1
    s_add_u32 s70, s70, 1
    s_cmp_lt_u32 s70, 480000
    s_cbranch_scc1 L_ls_v1
L_lsd_v1:
    ds_read_b64_tr_b16 v[192:193], v28 offset:0
    ds_read_b64_tr_b16 v[194:195], v28 offset:1024
    ds_read_b64_tr_b16 v[196:197], v29 offset:0
    ds_read_b64_tr_b16 v[198:199], v29 offset:1024
    ds_read_b64_tr_b16 v[200:201], v28 offset:2048
    ds_read_b64_tr_b16 v[202:203], v28 offset:3072
    ds_read_b64_tr_b16 v[204:205], v29 offset:2048
    ds_read_b64_tr_b16 v[206:207], v29 offset:3072
    ds_read_b64_tr_b16 v[208:209], v28 offset:4096
    ds_read_b64_tr_b16 v[210:211], v28 offset:5120
    ds_read_b64_tr_b16 v[212:213], v29 offset:4096
    ds_read_b64_tr_b16 v[214:215], v29 offset:5120
    s_waitcnt lgkmcnt(8)
    v_mfma_f32_32x32x16_bf16 v[48:63], v[128:131], v[192:195], 0
    v_mfma_f32_32x32x16_bf16 v[64:79], v[132:135], v[192:195], 0
    v_mfma_f32_32x32x16_bf16 v[80:95], v[128:131], v[196:199], 0
    v_mfma_f32_32x32x16_bf16 v[96:111], v[132:135], v[196:199], 0
    ds_read_b64_tr_b16 v[216:217], v28 offset:6144
    ds_read_b64_tr_b16 v[218:219], v28 offset:7168
    ds_read_b64_tr_b16 v[220:221], v29 offset:6144
    ds_read_b64_tr_b16 v[222:223], v29 offset:7168
    s_waitcnt lgkmcnt(8)
    v_mfma_f32_32x32x16_bf16 v[48:63], v[136:139], v[200:203], v[48:63]
    v_mfma_f32_32x32x16_bf16 v[64:79], v[140:143], v[200:203], v[64:79]
    v_mfma_f32_32x32x16_bf16 v[80:95], v[136:139], v[204:207], v[80:95]
    v_mfma_f32_32x32x16_bf16 v[96:111], v[140:143], v[204:207], v[96:111]
    s_add_u32 s60, s60, 16
    s_mov_b32 s70, 0
    v_mov_b32 v26, s60
    s_nop 8
L_ls_v2:
    ds_read_b32 v27, v26
    s_waitcnt lgkmcnt(0)
    v_cmp_ne_u32 vcc, s62, v27
    s_nop 4
    s_cbranch_vccz L_lsd_v2
    s_add_u32 s70, s70, 1
    s_cmp_lt_u32 s70, 480000
    s_cbranch_scc1 L_ls_v2
L_lsd_v2:
    ds_read_b64_tr_b16 v[192:193], v28 offset:8192
    ds_read_b64_tr_b16 v[194:195], v28 offset:9216
    ds_read_b64_tr_b16 v[196:197], v29 offset:8192
    ds_read_b64_tr_b16 v[198:199], v29 offset:9216
    s_waitcnt lgkmcnt(4)
    v_mfma_f32_32x32x16_bf16 v[48:63], v[144:147], v[208:211], v[48:63]
    v_mfma_f32_32x32x16_bf16 v[64:79], v[148:151], v[208:211], v[64:79]
    v_mfma_f32_32x32x16_bf16 v[80:95], v[144:147], v[212:215], v[80:95]
    v_mfma_f32_32x32x16_bf16 v[96:111], v[148:151], v[212:215], v[96:111]
    ds_read_b64_tr_b16 v[200:201], v28 offset:10240
    ds_read_b64_tr_b16 v[202:203], v28 offset:11264
    ds_read_b64_tr_b16 v[204:205], v29 offset:10240
    ds_read_b64_tr_b16 v[206:207], v29 offset:11264
    s_waitcnt lgkmcnt(8)
    v_mfma_f32_32x32x16_bf16 v[48:63], v[152:155], v[216:219], v[48:63]
    v_mfma_f32_32x32x16_bf16 v[64:79], v[156:159], v[216:219], v[64:79]
    v_mfma_f32_32x32x16_bf16 v[80:95], v[152:155], v[220:223], v[80:95]
    v_mfma_f32_32x32x16_bf16 v[96:111], v[156:159], v[220:223], v[96:111]
    ds_read_b64_tr_b16 v[208:209], v28 offset:12288
    ds_read_b64_tr_b16 v[210:211], v28 offset:13312
    ds_read_b64_tr_b16 v[212:213], v29 offset:12288
    ds_read_b64_tr_b16 v[214:215], v29 offset:13312
    s_waitcnt lgkmcnt(8)
    v_mfma_f32_32x32x16_bf16 v[48:63], v[160:163], v[192:195], v[48:63]
    v_mfma_f32_32x32x16_bf16 v[64:79], v[164:167], v[192:195], v[64:79]
    v_mfma_f32_32x32x16_bf16 v[80:95], v[160:163], v[196:199], v[80:95]
    v_mfma_f32_32x32x16_bf16 v[96:111], v[164:167], v[196:199], v[96:111]
    ds_read_b64_tr_b16 v[216:217], v28 offset:14336
    ds_read_b64_tr_b16 v[218:219], v28 offset:15360
    ds_read_b64_tr_b16 v[220:221], v29 offset:14336
    ds_read_b64_tr_b16 v[222:223], v29 offset:15360
    s_waitcnt lgkmcnt(8)
    v_mfma_f32_32x32x16_bf16 v[48:63], v[168:171], v[200:203], v[48:63]
    v_mfma_f32_32x32x16_bf16 v[64:79], v[172:175], v[200:203], v[64:79]
    v_mfma_f32_32x32x16_bf16 v[80:95], v[168:171], v[204:207], v[80:95]
    v_mfma_f32_32x32x16_bf16 v[96:111], v[172:175], v[204:207], v[96:111]
    s_waitcnt lgkmcnt(4)
    v_mfma_f32_32x32x16_bf16 v[48:63], v[176:179], v[208:211], v[48:63]
    v_mfma_f32_32x32x16_bf16 v[64:79], v[180:183], v[208:211], v[64:79]
    v_mfma_f32_32x32x16_bf16 v[80:95], v[176:179], v[212:215], v[80:95]
    v_mfma_f32_32x32x16_bf16 v[96:111], v[180:183], v[212:215], v[96:111]
    s_waitcnt lgkmcnt(0)
    v_mfma_f32_32x32x16_bf16 v[48:63], v[184:187], v[216:219], v[48:63]
    v_mfma_f32_32x32x16_bf16 v[64:79], v[188:191], v[216:219], v[64:79]
    v_mfma_f32_32x32x16_bf16 v[80:95], v[184:187], v[220:223], v[80:95]
    v_mfma_f32_32x32x16_bf16 v[96:111], v[188:191], v[220:223], v[96:111]
    s_mov_b32 s70, 0
    v_mov_b32 v26, 148792
    s_nop 9
L_ls_md:
    ds_read_b32 v27, v26
    s_waitcnt lgkmcnt(0)
    v_cmp_ne_u32 vcc, s62, v27
    s_nop 4
    s_cbranch_vccz L_lsd_md
    s_add_u32 s70, s70, 1
    s_cmp_lt_u32 s70, 480000
    s_cbranch_scc1 L_ls_md
L_lsd_md:
    v_mov_b32 v13, 148784
    ds_read_b32 v14, v13
    v_lshlrev_b32 v15, 2, v0
    v_add_u32 v16, 147456, v15
    ds_read_b32 v18, v16 offset:0
    ds_read_b32 v19, v16 offset:256
    ds_read_b32 v20, v16 offset:512
    ds_read_b32 v21, v16 offset:768
    v_cvt_pk_bf16_f32 v128, v48, v49
    v_cvt_pk_bf16_f32 v129, v50, v51
    v_cvt_pk_bf16_f32 v130, v52, v53
    v_cvt_pk_bf16_f32 v131, v54, v55
    v_cvt_pk_bf16_f32 v132, v56, v57
    v_cvt_pk_bf16_f32 v133, v58, v59
    v_cvt_pk_bf16_f32 v134, v60, v61
    v_cvt_pk_bf16_f32 v135, v62, v63
    v_cvt_pk_bf16_f32 v136, v64, v65
    v_cvt_pk_bf16_f32 v137, v66, v67
    v_cvt_pk_bf16_f32 v138, v68, v69
    v_cvt_pk_bf16_f32 v139, v70, v71
    v_cvt_pk_bf16_f32 v140, v72, v73
    v_cvt_pk_bf16_f32 v141, v74, v75
    v_cvt_pk_bf16_f32 v142, v76, v77
    v_cvt_pk_bf16_f32 v143, v78, v79
    v_cvt_pk_bf16_f32 v144, v80, v81
    v_cvt_pk_bf16_f32 v145, v82, v83
    v_cvt_pk_bf16_f32 v146, v84, v85
    v_cvt_pk_bf16_f32 v147, v86, v87
    v_cvt_pk_bf16_f32 v148, v88, v89
    v_cvt_pk_bf16_f32 v149, v90, v91
    v_cvt_pk_bf16_f32 v150, v92, v93
    v_cvt_pk_bf16_f32 v151, v94, v95
    v_cvt_pk_bf16_f32 v152, v96, v97
    v_cvt_pk_bf16_f32 v153, v98, v99
    v_cvt_pk_bf16_f32 v154, v100, v101
    v_cvt_pk_bf16_f32 v155, v102, v103
    v_cvt_pk_bf16_f32 v156, v104, v105
    v_cvt_pk_bf16_f32 v157, v106, v107
    v_cvt_pk_bf16_f32 v158, v108, v109
    v_cvt_pk_bf16_f32 v159, v110, v111
    s_lshl_b32 s59, s57, 13
    v_add_u32 v12, s59, v11
    s_lshl_b32 s71, s19, 15
    s_add_u32 s60, s71, 4096
    s_waitcnt lgkmcnt(0)
    v_readfirstlane_b32 s63, v14
    s_nop 2
    s_cmp_eq_u32 s63, s62
    s_cselect_b32 s63, 1, 0
    s_mov_b32 s70, 0
    v_and_b32 v26, 3, v0
    v_lshlrev_b32 v26, 2, v26
    v_add_u32 v26, 148848, v26
    s_nop 1
L_ls_qi:
    ds_read_b32 v27, v26
    s_waitcnt lgkmcnt(0)
    v_cmp_ne_u32 vcc, s62, v27
    s_nop 4
    s_cbranch_vccz L_lsd_qi
    s_add_u32 s70, s70, 1
    s_cmp_lt_u32 s70, 480000
    s_cbranch_scc1 L_ls_qi
L_lsd_qi:
    buffer_store_dwordx4 v[128:131], v12, s[40:43], s71 offen offset:0 sc1
    buffer_store_dwordx4 v[132:135], v12, s[40:43], s71 offen offset:1024 sc1
    buffer_store_dwordx4 v[136:139], v12, s[40:43], s71 offen offset:2048 sc1
    buffer_store_dwordx4 v[140:143], v12, s[40:43], s71 offen offset:3072 sc1
    buffer_store_dwordx4 v[144:147], v12, s[40:43], s60 offen offset:0 sc1
    buffer_store_dwordx4 v[148:151], v12, s[40:43], s60 offen offset:1024 sc1
    buffer_store_dwordx4 v[152:155], v12, s[40:43], s60 offen offset:2048 sc1
    buffer_store_dwordx4 v[156:159], v12, s[40:43], s60 offen offset:3072 sc1
    s_lshl_b32 s59, s57, 2
    s_add_u32 s59, s59, 148800
    v_mov_b32 v26, s59
    v_mov_b32 v27, s62
    ds_write_b32 v26, v27
    s_cmp_eq_u32 s57, 0
    s_cbranch_scc0 L_noz
    v_add_f32 v18, v18, v19
    v_add_f32 v20, v20, v21
    v_add_f32 v18, v18, v20
    s_lshl_b32 s71, s19, 8
    s_add_u32 s71, s71, 557056
    buffer_store_dword v18, v15, s[40:43], s71 offen sc1
L_noz:
    s_lshl_b32 s59, s19, 11
    s_lshl_b32 s60, s57, 9
    s_add_u32 s61, s59, s60
    v_and_b32 v72, 31, v0
    v_lshlrev_b32 v72, 4, v72
    v_add_u32 v72, s61, v72
    v_lshrrev_b32 v73, 5, v0
    v_lshl_add_u32 v73, v73, 15, v72
    s_and_b32 s61, s56, 3
    s_lshr_b32 s60, s56, 2
    v_bfe_u32 v21, v0, 2, 1
    v_lshlrev_b32 v21, 4, v21
    v_bfe_u32 v22, v0, 3, 2
    v_lshl_add_u32 v21, v22, 2, v21
    v_and_b32 v22, 3, v0
    v_add_u32 v21, v21, v22
    v_and_b32 v22, 32, v0
    v_add_u32 v21, v21, v22
    v_lshlrev_b32 v2, 4, v21
    s_lshl_b32 s59, s60, 15
    s_add_u32 s59, s59, 0
    v_add_u32 v3, s59, v11
    s_lshl_b32 s59, s60, 9
    s_add_u32 s59, s59, 149504
    v_lshlrev_b32 v4, 2, v0
    v_add_u32 v4, s59, v4
    s_lshl_b32 s59, s56, 13
    s_add_u32 s59, s59, 65536
    v_lshrrev_b32 v21, 5, v0
    v_lshlrev_b32 v22, 1, v21
    v_and_b32 v23, 7, v0
    v_xor_b32 v22, v22, v23
    v_lshlrev_b32 v22, 4, v22
    v_and_b32 v23, 31, v0
    v_lshl_add_u32 v5, v23, 7, v22
    v_add_u32 v5, s59, v5
    v_lshrrev_b32 v21, 3, v0
    v_and_b32 v22, 7, v0
    v_xor_b32 v23, v22, v21
    v_lshlrev_b32 v23, 4, v23
    v_lshl_add_u32 v6, v21, 7, v23
    v_add_u32 v6, s59, v6
    v_lshlrev_b32 v22, 4, v22
    v_lshl_add_u32 v7, v21, 9, v22
    s_lshl_b32 s59, s60, 15
    s_lshl_b32 s60, s61, 7
    s_add_u32 s59, s59, s60
    v_add_u32 v7, s59, v7
    s_lshl_b32 s92, s19, 4
    s_lshl_b32 s93, s57, 2
    s_add_u32 s92, s92, s93
    s_add_u32 s93, s92, 561664
    s_add_u32 s92, s92, 561408
    v_mov_b32 v8, 0
    v_mov_b32 v9, s62
    v_and_b32 v75, 31, v0
    v_and_b32 v76, 1, v75
    v_lshlrev_b32 v76, 4, v76
    v_mov_b32 v77, 0x3f80
    v_lshlrev_b32 v76, v76, v77
    v_lshrrev_b32 v75, 1, v75
    v_cmp_eq_u32 vcc, 0, v75
    s_nop 1
    v_cndmask_b32 v80, 0, v76, vcc
    v_cmp_eq_u32 vcc, 1, v75
    s_nop 1
    v_cndmask_b32 v81, 0, v76, vcc
    v_cmp_eq_u32 vcc, 2, v75
    s_nop 1
    v_cndmask_b32 v82, 0, v76, vcc
    v_cmp_eq_u32 vcc, 3, v75
    s_nop 1
    v_cndmask_b32 v83, 0, v76, vcc
    v_lshrrev_b32 v74, 5, v0
    v_lshl_add_u32 v74, v74, 3, v72
    s_waitcnt vmcnt(0)
    s_mov_b64 exec, 1
    s_cmp_lg_u32 s63, 0
    s_cbranch_scc1 L_fast1
    buffer_store_dword v9, v8, s[40:43], s92 offen sc1
    s_branch L_join1
L_fast1:
    buffer_store_dword v9, v8, s[40:43], s92 offen
L_join1:
    s_mov_b64 exec, -1
    s_mov_b32 s70, 0
    s_mov_b32 s60, 561408
    v_lshlrev_b32 v12, 2, v0
    s_nop 1
L_spin_h1:
    buffer_load_dword v13, v12, s[40:43], s60 offen sc1
    s_waitcnt vmcnt(0)
    v_cmp_ne_u32 vcc, s62, v13
    s_nop 4
    s_cbranch_vccz L_spun_h1
    s_cmp_lg_u32 s63, 0
    s_cbranch_scc1 L_nap_h1
    s_sleep 12
L_nap_h1:
    s_add_u32 s70, s70, 1
    s_cmp_lt_u32 s70, 60000
    s_cbranch_scc1 L_spin_h1
L_spun_h1:
    s_cmp_eq_u32 s57, 3
    s_cbranch_scc0 L_noz2
    s_mov_b32 s71, 557056
    buffer_load_dwordx4 v[192:195], v11, s[40:43], s71 offen offset:0 sc1
    buffer_load_dwordx4 v[196:199], v11, s[40:43], s71 offen offset:1024 sc1
    buffer_load_dwordx4 v[200:203], v11, s[40:43], s71 offen offset:2048 sc1
    buffer_load_dwordx4 v[204:207], v11, s[40:43], s71 offen offset:3072 sc1
L_noz2:
    s_mov_b32 s71, 0
    buffer_load_dwordx4 v[128:131], v73, s[40:43], s71 offen sc1
    s_add_u32 s71, s71, 65536
    buffer_load_dwordx4 v[132:135], v73, s[40:43], s71 offen sc1
    s_add_u32 s71, s71, 65536
    buffer_load_dwordx4 v[136:139], v73, s[40:43], s71 offen sc1
    s_add_u32 s71, s71, 65536
    buffer_load_dwordx4 v[140:143], v73, s[40:43], s71 offen sc1
    s_add_u32 s71, s71, 65536
    buffer_load_dwordx4 v[144:147], v73, s[40:43], s71 offen sc1
    s_add_u32 s71, s71, 65536
    buffer_load_dwordx4 v[148:151], v73, s[40:43], s71 offen sc1
    s_add_u32 s71, s71, 65536
    buffer_load_dwordx4 v[152:155], v73, s[40:43], s71 offen sc1
    s_add_u32 s71, s71, 65536
    buffer_load_dwordx4 v[156:159], v73, s[40:43], s71 offen sc1
    s_cmp_eq_u32 s57, 3
    s_cbranch_scc0 L_noz3
    s_waitcnt vmcnt(8)
    v_add_f32 v192, v192, v196
    v_add_f32 v200, v200, v204
    v_add_f32 v193, v193, v197
    v_add_f32 v201, v201, v205
    v_add_f32 v194, v194, v198
    v_add_f32 v202, v202, v206
    v_add_f32 v195, v195, v199
    v_add_f32 v203, v203, v207
    v_add_f32 v192, v192, v200
    v_add_f32 v193, v193, v201
    v_add_f32 v194, v194, v202
    v_add_f32 v195, v195, v203
    v_mov_b32 v196, v192
    v_mov_b32 v197, v193
    v_mov_b32 v198, v194
    v_mov_b32 v199, v195
    v_permlane32_swap_b32 v192, v196
    v_permlane32_swap_b32 v193, v197
    v_permlane32_swap_b32 v194, v198
    v_permlane32_swap_b32 v195, v199
    v_add_f32 v192, v192, v196
    v_add_f32 v193, v193, v197
    v_add_f32 v194, v194, v198
    v_add_f32 v195, v195, v199
    v_mov_b32 v196, v192
    v_mov_b32 v197, v193
    v_mov_b32 v198, v194
    v_mov_b32 v199, v195
    v_permlane16_swap_b32 v192, v196
    v_permlane16_swap_b32 v193, v197
    v_permlane16_swap_b32 v194, v198
    v_permlane16_swap_b32 v195, v199
    v_add_f32 v192, v192, v196
    v_add_f32 v193, v193, v197
    v_add_f32 v194, v194, v198
    v_add_f32 v195, v195, v199
    v_cvt_pk_bf16_f32 v192, v192, v193
    v_cvt_pk_bf16_f32 v193, v194, v195
    v_and_b32 v194, 15, v0
    v_lshlrev_b32 v194, 3, v194
    v_add_u32 v194, 148480, v194
    ds_write_b64 v194, v[192:193]
    s_waitcnt lgkmcnt(0)
    v_mov_b32 v20, 148788
    v_mov_b32 v21, s62
    ds_write_b32 v20, v21
    s_nop 0
L_noz3:
    s_mov_b32 s73, 0
    v_and_b32 v20, 1, v0
    v_lshlrev_b32 v20, 2, v20
    v_add_u32 v20, 148816, v20
    ds_read_b32 v21, v20
    s_waitcnt lgkmcnt(0)
    v_cmp_ne_u32 vcc, s62, v21
    s_nop 4
    s_cbranch_vccnz L_nopq
    ds_read_b128 v[32:35], v3 offset:0
    ds_read_b128 v[36:39], v3 offset:1024
    ds_read_b128 v[40:43], v3 offset:2048
    ds_read_b128 v[44:47], v3 offset:3072
    ds_read_b128 v[48:51], v3 offset:16384
    ds_read_b128 v[52:55], v3 offset:17408
    ds_read_b128 v[56:59], v3 offset:18432
    ds_read_b128 v[60:63], v3 offset:19456
    s_mov_b32 s73, 1
L_nopq:
    s_waitcnt vmcnt(7)
    v_mfma_f32_32x32x16_bf16 v[176:191], v[80:83], v[128:131], 0
    s_waitcnt vmcnt(6)
    v_mfma_f32_32x32x16_bf16 v[176:191], v[80:83], v[132:135], v[176:191]
    s_waitcnt vmcnt(5)
    v_mfma_f32_32x32x16_bf16 v[176:191], v[80:83], v[136:139], v[176:191]
    s_waitcnt vmcnt(4)
    v_mfma_f32_32x32x16_bf16 v[176:191], v[80:83], v[140:143], v[176:191]
    s_waitcnt vmcnt(3)
    v_mfma_f32_32x32x16_bf16 v[176:191], v[80:83], v[144:147], v[176:191]
    s_waitcnt vmcnt(2)
    v_mfma_f32_32x32x16_bf16 v[176:191], v[80:83], v[148:151], v[176:191]
    s_waitcnt vmcnt(1)
    v_mfma_f32_32x32x16_bf16 v[176:191], v[80:83], v[152:155], v[176:191]
    s_waitcnt vmcnt(0)
    v_mfma_f32_32x32x16_bf16 v[176:191], v[80:83], v[156:159], v[176:191]
    s_nop 11
    v_cvt_pk_bf16_f32 v176, v176, v177
    v_cvt_pk_bf16_f32 v177, v178, v179
    s_mov_b32 s71, 524288
    s_cmp_lg_u32 s63, 0
    s_cbranch_scc1 L_fast2
    buffer_store_dwordx2 v[176:177], v74, s[40:43], s71 offen sc1
    s_branch L_join2
L_fast2:
    buffer_store_dwordx2 v[176:177], v74, s[40:43], s71 offen
L_join2:
    s_waitcnt vmcnt(0)
    s_mov_b64 exec, 1
    s_cmp_lg_u32 s63, 0
    s_cbranch_scc1 L_fast3
    buffer_store_dword v9, v8, s[40:43], s93 offen sc1
    s_branch L_join3
L_fast3:
    buffer_store_dword v9, v8, s[40:43], s93 offen
L_join3:
    s_mov_b64 exec, -1
    s_cmp_eq_u32 s19, 0
    s_cbranch_scc0 L_noep
    s_cmp_eq_u32 s57, 1
    s_cbranch_scc0 L_noep
    s_mov_b64 exec, 1
    v_mov_b32 v12, 0
    v_mov_b32 v13, s62
    s_mov_b32 s59, 561152
    buffer_store_dword v13, v12, s[40:43], s59 offen sc1
    s_mov_b64 exec, -1
L_noep:
    s_cmp_eq_u32 s73, 1
    s_cbranch_scc1 L_pqdone
    s_lshr_b32 s59, s56, 2
    s_lshl_b32 s59, s59, 3
    s_add_u32 s71, s59, 148816
    s_mov_b32 s70, 0
    v_and_b32 v20, 1, v0
    v_lshlrev_b32 v20, 2, v20
    v_add_u32 v20, s71, v20
    s_nop 1
L_ls_pqa:
    ds_read_b32 v21, v20
    s_waitcnt lgkmcnt(0)
    v_cmp_ne_u32 vcc, s62, v21
    s_nop 4
    s_cbranch_vccz L_lsd_pqa
    s_add_u32 s70, s70, 1
    s_cmp_lt_u32 s70, 480000
    s_cbranch_scc1 L_ls_pqa
L_lsd_pqa:
    ds_read_b128 v[32:35], v3 offset:0
    ds_read_b128 v[36:39], v3 offset:1024
    ds_read_b128 v[40:43], v3 offset:2048
    ds_read_b128 v[44:47], v3 offset:3072
    ds_read_b128 v[48:51], v3 offset:16384
    ds_read_b128 v[52:55], v3 offset:17408
    ds_read_b128 v[56:59], v3 offset:18432
    ds_read_b128 v[60:63], v3 offset:19456
L_pqdone:
    s_branch L_final
L_team_b:
    ds_read_b128 v[128:131], v2 offset:0
    ds_read_b128 v[192:195], v2 offset:16384
    ds_read_b128 v[132:135], v3 offset:0
    ds_read_b128 v[196:199], v3 offset:16384
    ds_read_b128 v[136:139], v4 offset:0
    ds_read_b128 v[200:203], v4 offset:16384
    ds_read_b128 v[140:143], v5 offset:0
    ds_read_b128 v[204:207], v5 offset:16384
    ds_read_b128 v[144:147], v6 offset:0
    ds_read_b128 v[208:211], v6 offset:16384
    ds_read_b128 v[148:151], v7 offset:0
    ds_read_b128 v[212:215], v7 offset:16384
    ds_read_b128 v[152:155], v8 offset:0
    ds_read_b128 v[216:219], v8 offset:16384
    ds_read_b128 v[156:159], v9 offset:0
    ds_read_b128 v[220:223], v9 offset:16384
    ds_read_b128 v[160:163], v2 offset:256
    ds_read_b128 v[224:227], v2 offset:16640
    ds_read_b128 v[164:167], v3 offset:256
    ds_read_b128 v[228:231], v3 offset:16640
    ds_read_b128 v[168:171], v4 offset:256
    ds_read_b128 v[232:235], v4 offset:16640
    ds_read_b128 v[172:175], v5 offset:256
    ds_read_b128 v[236:239], v5 offset:16640
    ds_read_b128 v[176:179], v6 offset:256
    ds_read_b128 v[240:243], v6 offset:16640
    ds_read_b128 v[180:183], v7 offset:256
    ds_read_b128 v[244:247], v7 offset:16640
    ds_read_b128 v[184:187], v8 offset:256
    ds_read_b128 v[248:251], v8 offset:16640
    ds_read_b128 v[188:191], v9 offset:256
    ds_read_b128 v[252:255], v9 offset:16640
    s_lshl_b32 s59, s57, 14
    s_sub_u32 s59, s59, 131072
    v_add_u32 v2, s59, v2
    v_add_u32 v3, s59, v3
    v_add_u32 v4, s59, v4
    v_add_u32 v5, s59, v5
    v_add_u32 v6, s59, v6
    v_add_u32 v7, s59, v7
    v_add_u32 v8, s59, v8
    v_add_u32 v9, s59, v9
    s_waitcnt vmcnt(4) lgkmcnt(0)
    s_barrier
    s_barrier
    s_cmp_lt_u32 s57, 2
    s_cbranch_scc0 L_nopre
    s_lshl_b32 s59, s19, 11
    s_lshl_b32 s60, s57, 10
    s_add_u32 s59, s59, s60
    s_add_u32 s59, s59, 524288
    buffer_load_dwordx4 v[32:35], v11, s[40:43], s59 offen
L_nopre:
    s_mov_b32 s61, 8
    s_lshl_b32 s71, s61, 12
    s_lshl_b32 s59, s57, 7
    s_add_u32 s71, s71, s59
    s_lshl_b32 s59, s61, 10
    s_lshl_b32 s60, s57, 14
    s_add_u32 s59, s59, s60
    s_add_u32 s59, s59, 65536
    s_add_u32 m0, s59, 0
    s_nop 0
    buffer_load_dwordx4 v30, s[24:27], s71 offen nt lds
    s_add_u32 m0, s59, 1024
    s_add_u32 s71, s71, 4096
    buffer_load_dwordx4 v30, s[24:27], s71 offen nt lds
    s_add_u32 m0, s59, 2048
    s_add_u32 s71, s71, 4096
    buffer_load_dwordx4 v30, s[24:27], s71 offen nt lds
    s_add_u32 m0, s59, 3072
    s_add_u32 s71, s71, 4096
    buffer_load_dwordx4 v30, s[24:27], s71 offen nt lds
    s_add_u32 m0, s59, 4096
    s_add_u32 s71, s71, 4096
    buffer_load_dwordx4 v30, s[24:27], s71 offen nt lds
    s_add_u32 m0, s59, 5120
    s_add_u32 s71, s71, 4096
    buffer_load_dwordx4 v30, s[24:27], s71 offen nt lds
    s_add_u32 m0, s59, 6144
    s_add_u32 s71, s71, 4096
    buffer_load_dwordx4 v30, s[24:27], s71 offen nt lds
    s_add_u32 m0, s59, 7168
    s_add_u32 s71, s71, 4096
    buffer_load_dwordx4 v30, s[24:27], s71 offen nt lds
    s_lshl_b32 s71, s57, 14
    s_add_u32 m0, s71, 0
    s_nop 0
    buffer_load_dwordx4 v10, s[28:31], s71 offen offset:0 nt lds
    v_xor_b32 v12, 32, v10
    buffer_load_dwordx4 v12, s[28:31], s71 offen offset:1024 nt lds
    s_waitcnt vmcnt(10)
    s_lshl_b32 s61, s57, 2
    s_add_u32 s61, s61, 148752
    v_mov_b32 v76, s61
    v_mov_b32 v77, s62
    ds_write_b32 v76, v77
    s_cmp_eq_u32 s57, 0
    s_cbranch_scc0 L_nochk0e
    s_load_dwordx8 s[20:27], s[96:97], 561280 glc
    s_load_dwordx8 s[44:51], s[96:97], 561312 glc
L_nochk0e:
    v_xor_b32 v12, 64, v10
    buffer_load_dwordx4 v12, s[28:31], s71 offen offset:2048 nt lds
    v_xor_b32 v12, 96, v10
    buffer_load_dwordx4 v12, s[28:31], s71 offen offset:3072 nt lds
    s_add_u32 s71, s71, 4096
    s_add_u32 m0, s71, 0
    v_xor_b32 v12, 128, v10
    buffer_load_dwordx4 v12, s[28:31], s71 offen offset:0 nt lds
    v_xor_b32 v12, 160, v10
    buffer_load_dwordx4 v12, s[28:31], s71 offen offset:1024 nt lds
    v_xor_b32 v12, 192, v10
    buffer_load_dwordx4 v12, s[28:31], s71 offen offset:2048 nt lds
    v_xor_b32 v12, 224, v10
    buffer_load_dwordx4 v12, s[28:31], s71 offen offset:3072 nt lds
    s_waitcnt vmcnt(8)
    s_lshl_b32 s61, s57, 2
    s_add_u32 s61, s61, 148768
    v_mov_b32 v76, s61
    v_mov_b32 v77, s62
    ds_write_b32 v76, v77
    s_cmp_eq_u32 s57, 0
    s_cbranch_scc0 L_nochk1
    s_mov_b32 s70, 0
L_chk:
    s_waitcnt lgkmcnt(0)
    s_mov_b32 s59, s62
    s_not_b32 s60, s62
    s_mov_b32 s61, 1
    s_cmp_eq_u32 s20, s95
    s_cselect_b32 s59, s59, s60
    s_lshr_b32 s20, s20, 4
    s_lshr_b32 s63, s95, 4
    s_cmp_eq_u32 s20, s63
    s_cselect_b32 s61, s61, 0
    s_cmp_eq_u32 s21, s95
    s_cselect_b32 s59, s59, s60
    s_lshr_b32 s21, s21, 4
    s_lshr_b32 s63, s95, 4
    s_cmp_eq_u32 s21, s63
    s_cselect_b32 s61, s61, 0
    s_cmp_eq_u32 s22, s95
    s_cselect_b32 s59, s59, s60
    s_lshr_b32 s22, s22, 4
    s_lshr_b32 s63, s95, 4
    s_cmp_eq_u32 s22, s63
    s_cselect_b32 s61, s61, 0
    s_cmp_eq_u32 s23, s95
    s_cselect_b32 s59, s59, s60
    s_lshr_b32 s23, s23, 4
    s_lshr_b32 s63, s95, 4
    s_cmp_eq_u32 s23, s63
    s_cselect_b32 s61, s61, 0
    s_cmp_eq_u32 s24, s95
    s_cselect_b32 s59, s59, s60
    s_lshr_b32 s24, s24, 4
    s_lshr_b32 s63, s95, 4
    s_cmp_eq_u32 s24, s63
    s_cselect_b32 s61, s61, 0
    s_cmp_eq_u32 s25, s95
    s_cselect_b32 s59, s59, s60
    s_lshr_b32 s25, s25, 4
    s_lshr_b32 s63, s95, 4
    s_cmp_eq_u32 s25, s63
    s_cselect_b32 s61, s61, 0
    s_cmp_eq_u32 s26, s95
    s_cselect_b32 s59, s59, s60
    s_lshr_b32 s26, s26, 4
    s_lshr_b32 s63, s95, 4
    s_cmp_eq_u32 s26, s63
    s_cselect_b32 s61, s61, 0
    s_cmp_eq_u32 s27, s95
    s_cselect_b32 s59, s59, s60
    s_lshr_b32 s27, s27, 4
    s_lshr_b32 s63, s95, 4
    s_cmp_eq_u32 s27, s63
    s_cselect_b32 s61, s61, 0
    s_cmp_eq_u32 s44, s95
    s_cselect_b32 s59, s59, s60
    s_lshr_b32 s44, s44, 4
    s_lshr_b32 s63, s95, 4
    s_cmp_eq_u32 s44, s63
    s_cselect_b32 s61, s61, 0
    s_cmp_eq_u32 s45, s95
    s_cselect_b32 s59, s59, s60
    s_lshr_b32 s45, s45, 4
    s_lshr_b32 s63, s95, 4
    s_cmp_eq_u32 s45, s63
    s_cselect_b32 s61, s61, 0
    s_cmp_eq_u32 s46, s95
    s_cselect_b32 s59, s59, s60
    s_lshr_b32 s46, s46, 4
    s_lshr_b32 s63, s95, 4
    s_cmp_eq_u32 s46, s63
    s_cselect_b32 s61, s61, 0
    s_cmp_eq_u32 s47, s95
    s_cselect_b32 s59, s59, s60
    s_lshr_b32 s47, s47, 4
    s_lshr_b32 s63, s95, 4
    s_cmp_eq_u32 s47, s63
    s_cselect_b32 s61, s61, 0
    s_cmp_eq_u32 s48, s95
    s_cselect_b32 s59, s59, s60
    s_lshr_b32 s48, s48, 4
    s_lshr_b32 s63, s95, 4
    s_cmp_eq_u32 s48, s63
    s_cselect_b32 s61, s61, 0
    s_cmp_eq_u32 s49, s95
    s_cselect_b32 s59, s59, s60
    s_lshr_b32 s49, s49, 4
    s_lshr_b32 s63, s95, 4
    s_cmp_eq_u32 s49, s63
    s_cselect_b32 s61, s61, 0
    s_cmp_eq_u32 s50, s95
    s_cselect_b32 s59, s59, s60
    s_lshr_b32 s50, s50, 4
    s_lshr_b32 s63, s95, 4
    s_cmp_eq_u32 s50, s63
    s_cselect_b32 s61, s61, 0
    s_cmp_eq_u32 s51, s95
    s_cselect_b32 s59, s59, s60
    s_lshr_b32 s51, s51, 4
    s_lshr_b32 s63, s95, 4
    s_cmp_eq_u32 s51, s63
    s_cselect_b32 s61, s61, 0
    s_cmp_eq_u32 s61, 1
    s_cbranch_scc1 L_chkd
    s_add_u32 s70, s70, 1
    s_cmp_ge_u32 s70, 12
    s_cbranch_scc1 L_chkd
    s_load_dwordx8 s[20:27], s[96:97], 561280 glc
    s_load_dwordx8 s[44:51], s[96:97], 561312 glc
    s_branch L_chk
L_chkd:
    v_mov_b32 v76, 148784
    v_mov_b32 v77, s59
    ds_write_b32 v76, v77
    v_mov_b32 v76, 148792
    v_mov_b32 v77, s62
    ds_write_b32 v76, v77
    s_waitcnt lgkmcnt(0)
L_nochk1:
    s_add_u32 s71, s71, 4096
    s_add_u32 m0, s71, 0
    s_nop 0
    buffer_load_dwordx4 v10, s[28:31], s71 offen offset:0 nt lds
    v_xor_b32 v12, 32, v10
    buffer_load_dwordx4 v12, s[28:31], s71 offen offset:1024 nt lds
    v_xor_b32 v12, 64, v10
    buffer_load_dwordx4 v12, s[28:31], s71 offen offset:2048 nt lds
    v_xor_b32 v12, 96, v10
    buffer_load_dwordx4 v12, s[28:31], s71 offen offset:3072 nt lds
    s_lshl_b32 s61, s57, 2
    s_add_u32 s61, s61, 148848
    v_mov_b32 v76, s61
    v_mov_b32 v77, s62
    ds_write_b32 v76, v77
    s_mov_b32 s70, 0
    v_and_b32 v76, 3, v0
    v_lshlrev_b32 v76, 2, v76
    v_add_u32 v76, 148800, v76
    s_nop 1
L_ls_hq:
    ds_read_b32 v77, v76
    s_waitcnt lgkmcnt(0)
    v_cmp_ne_u32 vcc, s62, v77
    s_nop 4
    s_cbranch_vccz L_lsd_hq
    s_add_u32 s70, s70, 1
    s_cmp_lt_u32 s70, 480000
    s_cbranch_scc1 L_ls_hq
L_lsd_hq:
    s_add_u32 s71, s71, 4096
    s_add_u32 m0, s71, 0
    v_xor_b32 v12, 128, v10
    buffer_load_dwordx4 v12, s[28:31], s71 offen offset:0 nt lds
    v_xor_b32 v12, 160, v10
    buffer_load_dwordx4 v12, s[28:31], s71 offen offset:1024 nt lds
    v_xor_b32 v12, 192, v10
    buffer_load_dwordx4 v12, s[28:31], s71 offen offset:2048 nt lds
    v_xor_b32 v12, 224, v10
    buffer_load_dwordx4 v12, s[28:31], s71 offen offset:3072 nt lds
    v_lshlrev_b32 v78, 7, v0
    s_lshl_b32 s59, s57, 11
    s_add_u32 s59, s59, 4608
    v_add_u32 v78, s59, v78
    v_min_u32 v78, 11648, v78
    global_load_dword v1, v78, s[100:101]
    s_waitcnt vmcnt(1)
    ds_read_b128 v[32:35], v2 offset:0
    ds_read_b128 v[36:39], v3 offset:0
    ds_read_b128 v[40:43], v4 offset:0
    ds_read_b128 v[44:47], v5 offset:0
    ds_read_b128 v[48:51], v6 offset:0
    ds_read_b128 v[52:55], v7 offset:0
    ds_read_b128 v[56:59], v8 offset:0
    ds_read_b128 v[60:63], v9 offset:0
    ds_read_b128 v[64:67], v2 offset:256
    ds_read_b128 v[68:71], v3 offset:256
    ds_read_b128 v[72:75], v4 offset:256
    ds_read_b128 v[76:79], v5 offset:256
    ds_read_b128 v[80:83], v6 offset:256
    ds_read_b128 v[84:87], v7 offset:256
    ds_read_b128 v[88:91], v8 offset:256
    ds_read_b128 v[92:95], v9 offset:256
    v_mov_b32 v28, 0
    v_mov_b32 v29, 0
    v_mov_b32 v30, 0
    v_mov_b32 v31, 0
    s_waitcnt lgkmcnt(0)
    v_dot2c_f32_bf16 v28, v32, v32
    v_dot2c_f32_bf16 v29, v33, v33
    v_dot2c_f32_bf16 v30, v34, v34
    v_dot2c_f32_bf16 v31, v35, v35
    v_dot2c_f32_bf16 v28, v36, v36
    v_dot2c_f32_bf16 v29, v37, v37
    v_dot2c_f32_bf16 v30, v38, v38
    v_dot2c_f32_bf16 v31, v39, v39
    v_dot2c_f32_bf16 v28, v40, v40
    v_dot2c_f32_bf16 v29, v41, v41
    v_dot2c_f32_bf16 v30, v42, v42
    v_dot2c_f32_bf16 v31, v43, v43
    v_dot2c_f32_bf16 v28, v44, v44
    v_dot2c_f32_bf16 v29, v45, v45
    v_dot2c_f32_bf16 v30, v46, v46
    v_dot2c_f32_bf16 v31, v47, v47
    v_dot2c_f32_bf16 v28, v48, v48
    v_dot2c_f32_bf16 v29, v49, v49
    v_dot2c_f32_bf16 v30, v50, v50
    v_dot2c_f32_bf16 v31, v51, v51
    v_dot2c_f32_bf16 v28, v52, v52
    v_dot2c_f32_bf16 v29, v53, v53
    v_dot2c_f32_bf16 v30, v54, v54
    v_dot2c_f32_bf16 v31, v55, v55
    v_dot2c_f32_bf16 v28, v56, v56
    v_dot2c_f32_bf16 v29, v57, v57
    v_dot2c_f32_bf16 v30, v58, v58
    v_dot2c_f32_bf16 v31, v59, v59
    v_dot2c_f32_bf16 v28, v60, v60
    v_dot2c_f32_bf16 v29, v61, v61
    v_dot2c_f32_bf16 v30, v62, v62
    v_dot2c_f32_bf16 v31, v63, v63
    v_dot2c_f32_bf16 v28, v64, v64
    v_dot2c_f32_bf16 v29, v65, v65
    v_dot2c_f32_bf16 v30, v66, v66
    v_dot2c_f32_bf16 v31, v67, v67
    v_dot2c_f32_bf16 v28, v68, v68
    v_dot2c_f32_bf16 v29, v69, v69
    v_dot2c_f32_bf16 v30, v70, v70
    v_dot2c_f32_bf16 v31, v71, v71
    v_dot2c_f32_bf16 v28, v72, v72
    v_dot2c_f32_bf16 v29, v73, v73
    v_dot2c_f32_bf16 v30, v74, v74
    v_dot2c_f32_bf16 v31, v75, v75
    v_dot2c_f32_bf16 v28, v76, v76
    v_dot2c_f32_bf16 v29, v77, v77
    v_dot2c_f32_bf16 v30, v78, v78
    v_dot2c_f32_bf16 v31, v79, v79
    v_dot2c_f32_bf16 v28, v80, v80
    v_dot2c_f32_bf16 v29, v81, v81
    v_dot2c_f32_bf16 v30, v82, v82
    v_dot2c_f32_bf16 v31, v83, v83
    v_dot2c_f32_bf16 v28, v84, v84
    v_dot2c_f32_bf16 v29, v85, v85
    v_dot2c_f32_bf16 v30, v86, v86
    v_dot2c_f32_bf16 v31, v87, v87
    v_dot2c_f32_bf16 v28, v88, v88
    v_dot2c_f32_bf16 v29, v89, v89
    v_dot2c_f32_bf16 v30, v90, v90
    v_dot2c_f32_bf16 v31, v91, v91
    v_dot2c_f32_bf16 v28, v92, v92
    v_dot2c_f32_bf16 v29, v93, v93
    v_dot2c_f32_bf16 v30, v94, v94
    v_dot2c_f32_bf16 v31, v95, v95
    v_mfma_f32_32x32x16_bf16 v[96:111], v[128:131], v[32:35], 0
    s_and_b32 s61, s56, 3
    s_lshr_b32 s60, s56, 2
    v_bfe_u32 v21, v0, 2, 1
    v_mfma_f32_32x32x16_bf16 v[96:111], v[132:135], v[36:39], v[96:111]
    v_add_f32 v28, v28, v29
    v_add_f32 v30, v30, v31
    v_lshlrev_b32 v21, 4, v21
    v_bfe_u32 v22, v0, 3, 2
    v_lshl_add_u32 v21, v22, 2, v21
    v_mfma_f32_32x32x16_bf16 v[96:111], v[136:139], v[40:43], v[96:111]
    v_add_f32 v28, v28, v30
    v_and_b32 v22, 3, v0
    v_add_u32 v21, v21, v22
    v_and_b32 v22, 32, v0
    v_mfma_f32_32x32x16_bf16 v[96:111], v[140:143], v[44:47], v[96:111]
    v_mov_b32 v29, v28
    v_add_u32 v21, v21, v22
    v_lshlrev_b32 v2, 4, v21
    s_lshl_b32 s59, s60, 15
    v_mfma_f32_32x32x16_bf16 v[96:111], v[144:147], v[48:51], v[96:111]
    v_permlane32_swap_b32 v28, v29
    s_add_u32 s59, s59, 0
    v_add_u32 v3, s59, v11
    s_lshl_b32 s59, s60, 9
    v_mfma_f32_32x32x16_bf16 v[96:111], v[148:151], v[52:55], v[96:111]
    v_add_f32 v28, v28, v29
    s_add_u32 s59, s59, 149504
    v_lshlrev_b32 v4, 2, v0
    v_add_u32 v4, s59, v4
    v_mfma_f32_32x32x16_bf16 v[96:111], v[152:155], v[56:59], v[96:111]
    v_mul_f32 v28, s73, v28
    s_lshl_b32 s59, s56, 13
    s_add_u32 s59, s59, 65536
    v_lshrrev_b32 v21, 5, v0
    v_mfma_f32_32x32x16_bf16 v[96:111], v[156:159], v[60:63], v[96:111]
    v_mul_f32 v28, s66, v28
    v_lshlrev_b32 v22, 1, v21
    v_and_b32 v23, 7, v0
    v_xor_b32 v22, v22, v23
    v_mfma_f32_32x32x16_bf16 v[96:111], v[160:163], v[64:67], v[96:111]
    s_mov_b32 s64, 0x3eb8aa3b
    v_lshlrev_b32 v22, 4, v22
    v_and_b32 v23, 31, v0
    v_lshl_add_u32 v5, v23, 7, v22
    v_mfma_f32_32x32x16_bf16 v[96:111], v[164:167], v[68:71], v[96:111]
    v_mov_b32 v31, s72
    v_add_u32 v5, s59, v5
    v_lshrrev_b32 v21, 3, v0
    v_and_b32 v22, 7, v0
    v_mfma_f32_32x32x16_bf16 v[96:111], v[168:171], v[72:75], v[96:111]
    v_xor_b32 v23, v22, v21
    v_lshlrev_b32 v23, 4, v23
    v_lshl_add_u32 v6, v21, 7, v23
    v_mfma_f32_32x32x16_bf16 v[96:111], v[172:175], v[76:79], v[96:111]
    v_add_u32 v6, s59, v6
    v_lshlrev_b32 v22, 4, v22
    v_lshl_add_u32 v7, v21, 9, v22
    v_mfma_f32_32x32x16_bf16 v[96:111], v[176:179], v[80:83], v[96:111]
    s_lshl_b32 s59, s60, 15
    s_lshl_b32 s60, s61, 7
    s_add_u32 s59, s59, s60
    v_mfma_f32_32x32x16_bf16 v[96:111], v[180:183], v[84:87], v[96:111]
    v_add_u32 v7, s59, v7
    v_mfma_f32_32x32x16_bf16 v[96:111], v[184:187], v[88:91], v[96:111]
    v_mfma_f32_32x32x16_bf16 v[96:111], v[188:191], v[92:95], v[96:111]
    v_mfma_f32_32x32x16_bf16 v[112:127], v[192:195], v[32:35], 0
    v_mfma_f32_32x32x16_bf16 v[112:127], v[196:199], v[36:39], v[112:127]
    s_nop 9
    v_fma_f32 v20, v96, s64, v28
    v_fma_f32 v21, v97, s64, v28
    v_fma_f32 v22, v98, s64, v28
    v_fma_f32 v23, v99, s64, v28
    v_mfma_f32_32x32x16_bf16 v[112:127], v[200:203], v[40:43], v[112:127]
    v_fma_f32 v24, v100, s64, v28
    v_fma_f32 v25, v101, s64, v28
    v_fma_f32 v26, v102, s64, v28
    v_fma_f32 v27, v103, s64, v28
    v_mfma_f32_32x32x16_bf16 v[112:127], v[204:207], v[44:47], v[112:127]
    v_exp_f32 v20, v20
    v_exp_f32 v21, v21
    v_exp_f32 v22, v22
    v_exp_f32 v23, v23
    v_mfma_f32_32x32x16_bf16 v[112:127], v[208:211], v[48:51], v[112:127]
    v_exp_f32 v24, v24
    v_exp_f32 v25, v25
    v_exp_f32 v26, v26
    v_exp_f32 v27, v27
    v_mfma_f32_32x32x16_bf16 v[112:127], v[212:215], v[52:55], v[112:127]
    v_fma_f32 v20, v20, s67, v31
    v_fma_f32 v21, v21, s67, v31
    v_fma_f32 v22, v22, s67, v31
    v_fma_f32 v23, v23, s67, v31
    v_mfma_f32_32x32x16_bf16 v[112:127], v[216:219], v[56:59], v[112:127]
    v_fma_f32 v24, v24, s67, v31
    v_fma_f32 v25, v25, s67, v31
    v_fma_f32 v26, v26, s67, v31
    v_fma_f32 v27, v27, s67, v31
    v_mfma_f32_32x32x16_bf16 v[112:127], v[220:223], v[60:63], v[112:127]
    v_cvt_pk_bf16_f32 v12, v20, v21
    v_cvt_pk_bf16_f32 v13, v22, v23
    v_cvt_pk_bf16_f32 v14, v24, v25
    v_cvt_pk_bf16_f32 v15, v26, v27
    v_mfma_f32_32x32x16_bf16 v[112:127], v[224:227], v[64:67], v[112:127]
    v_fma_f32 v20, v104, s64, v28
    v_fma_f32 v21, v105, s64, v28
    v_fma_f32 v22, v106, s64, v28
    v_fma_f32 v23, v107, s64, v28
    v_mfma_f32_32x32x16_bf16 v[112:127], v[228:231], v[68:71], v[112:127]
    v_fma_f32 v24, v108, s64, v28
    v_fma_f32 v25, v109, s64, v28
    v_fma_f32 v26, v110, s64, v28
    v_fma_f32 v27, v111, s64, v28
    v_mfma_f32_32x32x16_bf16 v[112:127], v[232:235], v[72:75], v[112:127]
    v_exp_f32 v20, v20
    v_exp_f32 v21, v21
    v_exp_f32 v22, v22
    v_exp_f32 v23, v23
    v_mfma_f32_32x32x16_bf16 v[112:127], v[236:239], v[76:79], v[112:127]
    v_exp_f32 v24, v24
    v_exp_f32 v25, v25
    v_exp_f32 v26, v26
    v_exp_f32 v27, v27
    v_mfma_f32_32x32x16_bf16 v[112:127], v[240:243], v[80:83], v[112:127]
    v_fma_f32 v20, v20, s67, v31
    v_fma_f32 v21, v21, s67, v31
    v_fma_f32 v22, v22, s67, v31
    v_fma_f32 v23, v23, s67, v31
    v_mfma_f32_32x32x16_bf16 v[112:127], v[244:247], v[84:87], v[112:127]
    v_fma_f32 v24, v24, s67, v31
    v_fma_f32 v25, v25, s67, v31
    v_fma_f32 v26, v26, s67, v31
    v_fma_f32 v27, v27, s67, v31
    v_mfma_f32_32x32x16_bf16 v[112:127], v[248:251], v[88:91], v[112:127]
    v_cvt_pk_bf16_f32 v16, v20, v21
    v_cvt_pk_bf16_f32 v17, v22, v23
    v_cvt_pk_bf16_f32 v18, v24, v25
    v_cvt_pk_bf16_f32 v19, v26, v27
    v_mfma_f32_32x32x16_bf16 v[112:127], v[252:255], v[92:95], v[112:127]
    s_nop 11
    v_fma_f32 v20, v112, s64, v28
    v_fma_f32 v21, v113, s64, v28
    v_fma_f32 v22, v114, s64, v28
    v_fma_f32 v23, v115, s64, v28
    v_fma_f32 v24, v116, s64, v28
    v_fma_f32 v25, v117, s64, v28
    v_fma_f32 v26, v118, s64, v28
    v_fma_f32 v27, v119, s64, v28
    v_exp_f32 v20, v20
    v_exp_f32 v21, v21
    v_exp_f32 v22, v22
    v_exp_f32 v23, v23
    v_exp_f32 v24, v24
    v_exp_f32 v25, v25
    v_exp_f32 v26, v26
    v_exp_f32 v27, v27
    v_fma_f32 v20, v20, s67, v31
    v_fma_f32 v21, v21, s67, v31
    v_fma_f32 v22, v22, s67, v31
    v_fma_f32 v23, v23, s67, v31
    v_fma_f32 v24, v24, s67, v31
    v_fma_f32 v25, v25, s67, v31
    v_fma_f32 v26, v26, s67, v31
    v_fma_f32 v27, v27, s67, v31
    v_cvt_pk_bf16_f32 v104, v20, v21
    v_cvt_pk_bf16_f32 v105, v22, v23
    v_cvt_pk_bf16_f32 v106, v24, v25
    v_cvt_pk_bf16_f32 v107, v26, v27
    v_fma_f32 v20, v120, s64, v28
    v_fma_f32 v21, v121, s64, v28
    v_fma_f32 v22, v122, s64, v28
    v_fma_f32 v23, v123, s64, v28
    v_fma_f32 v24, v124, s64, v28
    v_fma_f32 v25, v125, s64, v28
    v_fma_f32 v26, v126, s64, v28
    v_fma_f32 v27, v127, s64, v28
    v_exp_f32 v20, v20
    v_exp_f32 v21, v21
    v_exp_f32 v22, v22
    v_exp_f32 v23, v23
    v_exp_f32 v24, v24
    v_exp_f32 v25, v25
    v_exp_f32 v26, v26
    v_exp_f32 v27, v27
    v_fma_f32 v20, v20, s67, v31
    v_fma_f32 v21, v21, s67, v31
    v_fma_f32 v22, v22, s67, v31
    v_fma_f32 v23, v23, s67, v31
    v_fma_f32 v24, v24, s67, v31
    v_fma_f32 v25, v25, s67, v31
    v_fma_f32 v26, v26, s67, v31
    v_fma_f32 v27, v27, s67, v31
    v_cvt_pk_bf16_f32 v108, v20, v21
    v_cvt_pk_bf16_f32 v109, v22, v23
    v_cvt_pk_bf16_f32 v110, v24, v25
    v_cvt_pk_bf16_f32 v111, v26, v27
    v_mov_b32 v96, v12
    v_mov_b32 v97, v13
    v_mov_b32 v98, v14
    v_mov_b32 v99, v15
    v_mov_b32 v100, v16
    v_mov_b32 v101, v17
    v_mov_b32 v102, v18
    v_mov_b32 v103, v19
    s_lshl_b32 s59, s57, 14
    s_add_u32 s59, s59, 0
    v_add_u32 v72, s59, v11
    ds_write_b128 v72, v[96:99] offset:0
    ds_write_b128 v72, v[100:103] offset:1024
    ds_write_b128 v72, v[104:107] offset:2048
    ds_write_b128 v72, v[108:111] offset:3072
    s_waitcnt lgkmcnt(0)
    s_lshl_b32 s59, s57, 2
    s_add_u32 s59, s59, 148816
    v_mov_b32 v76, s59
    v_mov_b32 v77, s62
    ds_write_b32 v76, v77
    s_lshr_b32 s59, s56, 2
    s_lshl_b32 s59, s59, 3
    s_add_u32 s71, s59, 148816
    s_mov_b32 s70, 0
    v_and_b32 v20, 1, v0
    v_lshlrev_b32 v20, 2, v20
    v_add_u32 v20, s71, v20
    s_nop 1
L_ls_pqb:
    ds_read_b32 v21, v20
    s_waitcnt lgkmcnt(0)
    v_cmp_ne_u32 vcc, s62, v21
    s_nop 4
    s_cbranch_vccz L_lsd_pqb
    s_add_u32 s70, s70, 1
    s_cmp_lt_u32 s70, 480000
    s_cbranch_scc1 L_ls_pqb
L_lsd_pqb:
    ds_read_b128 v[32:35], v3 offset:0
    ds_read_b128 v[36:39], v3 offset:1024
    ds_read_b128 v[40:43], v3 offset:2048
    ds_read_b128 v[44:47], v3 offset:3072
    ds_read_b128 v[48:51], v3 offset:16384
    ds_read_b128 v[52:55], v3 offset:17408
    ds_read_b128 v[56:59], v3 offset:18432
    ds_read_b128 v[60:63], v3 offset:19456
    s_mov_b32 s70, 0
    v_mov_b32 v20, 148788
    s_nop 1
L_ls_z:
    ds_read_b32 v21, v20
    s_waitcnt lgkmcnt(0)
    v_cmp_ne_u32 vcc, s62, v21
    s_nop 4
    s_cbranch_vccz L_lsd_z
    s_add_u32 s70, s70, 1
    s_cmp_lt_u32 s70, 480000
    s_cbranch_scc1 L_ls_z
L_lsd_z:
    v_lshrrev_b32 v24, 5, v0
    v_lshlrev_b32 v24, 3, v24
    v_add_u32 v24, 148480, v24
    ds_read2_b64 v[112:115], v24 offset0:0 offset1:2
    ds_read2_b64 v[116:119], v24 offset0:4 offset1:6
    ds_read2_b64 v[120:123], v24 offset0:8 offset1:10
    ds_read2_b64 v[124:127], v24 offset0:12 offset1:14
    v_mov_b32 v26, 0
    v_mov_b32 v27, 0
    s_waitcnt lgkmcnt(0)
    v_dot2c_f32_bf16 v26, v96, v112
    v_dot2c_f32_bf16 v27, v97, v113
    v_dot2c_f32_bf16 v26, v98, v114
    v_dot2c_f32_bf16 v27, v99, v115
    v_dot2c_f32_bf16 v26, v100, v116
    v_dot2c_f32_bf16 v27, v101, v117
    v_dot2c_f32_bf16 v26, v102, v118
    v_dot2c_f32_bf16 v27, v103, v119
    v_dot2c_f32_bf16 v26, v104, v120
    v_dot2c_f32_bf16 v27, v105, v121
    v_dot2c_f32_bf16 v26, v106, v122
    v_dot2c_f32_bf16 v27, v107, v123
    v_dot2c_f32_bf16 v26, v108, v124
    v_dot2c_f32_bf16 v27, v109, v125
    v_dot2c_f32_bf16 v26, v110, v126
    v_dot2c_f32_bf16 v27, v111, v127
    s_nop 2
    v_add_f32 v24, v26, v27
    v_mov_b32 v25, v24
    s_nop 1
    v_permlane32_swap_b32 v24, v25
    v_add_f32 v24, v24, v25
    v_cvt_pk_bf16_f32 v24, v24, v24
    v_lshlrev_b32 v24, 16, v24
    v_add_f32 v24, s72, v24
    v_cvt_pk_bf16_f32 v24, v24, v24
    v_lshlrev_b32 v24, 16, v24
    v_rcp_f32 v28, v24
    s_nop 0
    v_fma_f32 v25, -v24, v28, 1.0
    v_fma_f32 v28, v25, v28, v28
    s_lshl_b32 s59, s57, 8
    s_add_u32 s59, s59, 149504
    v_lshlrev_b32 v24, 2, v0
    v_add_u32 v24, s59, v24
    ds_write_b32 v24, v28
    s_waitcnt lgkmcnt(0)
    s_lshl_b32 s59, s57, 2
    s_add_u32 s59, s59, 148832
    v_mov_b32 v76, s59
    v_mov_b32 v77, s62
    ds_write_b32 v76, v77
    v_mov_b32 v24, 148784
    ds_read_b32 v25, v24
    s_waitcnt lgkmcnt(0)
    v_readfirstlane_b32 s63, v25
    s_nop 2
    s_cmp_eq_u32 s63, s62
    s_cselect_b32 s63, 1, 0
L_final:
    s_and_b32 s61, s56, 3
    s_lshl_b32 s60, s61, 6
    s_add_u32 s60, s60, 561664
    s_mov_b32 s70, 0
    v_and_b32 v20, 15, v0
    v_lshlrev_b32 v20, 2, v20
    s_nop 1
L_spin_h2:
    buffer_load_dword v21, v20, s[40:43], s60 offen sc1
    s_waitcnt vmcnt(0)
    v_cmp_ne_u32 vcc, s62, v21
    s_nop 4
    s_cbranch_vccz L_spun_h2
    s_cmp_lg_u32 s63, 0
    s_cbranch_scc1 L_nap_h2
    s_sleep 12
L_nap_h2:
    s_add_u32 s70, s70, 1
    s_cmp_lt_u32 s70, 60000
    s_cbranch_scc1 L_spin_h2
L_spun_h2:
    s_lshl_b32 s59, s61, 13
    s_add_u32 s59, s59, 524288
    s_add_u32 s60, s59, 4096
    buffer_load_dwordx4 v[64:67], v2, s[40:43], s59 offen offset:0 sc1
    buffer_load_dwordx4 v[68:71], v2, s[40:43], s59 offen offset:1024 sc1
    buffer_load_dwordx4 v[72:75], v2, s[40:43], s59 offen offset:2048 sc1
    buffer_load_dwordx4 v[76:79], v2, s[40:43], s59 offen offset:3072 sc1
    buffer_load_dwordx4 v[80:83], v2, s[40:43], s60 offen offset:0 sc1
    buffer_load_dwordx4 v[84:87], v2, s[40:43], s60 offen offset:1024 sc1
    buffer_load_dwordx4 v[88:91], v2, s[40:43], s60 offen offset:2048 sc1
    buffer_load_dwordx4 v[92:95], v2, s[40:43], s60 offen offset:3072 sc1
    s_lshr_b32 s59, s56, 2
    s_lshl_b32 s59, s59, 3
    s_add_u32 s71, s59, 148832
    s_mov_b32 s70, 0
    v_and_b32 v20, 1, v0
    v_lshlrev_b32 v20, 2, v20
    v_add_u32 v20, s71, v20
    s_nop 1
L_ls_rd:
    ds_read_b32 v21, v20
    s_waitcnt lgkmcnt(0)
    v_cmp_ne_u32 vcc, s62, v21
    s_nop 4
    s_cbranch_vccz L_lsd_rd
    s_add_u32 s70, s70, 1
    s_cmp_lt_u32 s70, 480000
    s_cbranch_scc1 L_ls_rd
L_lsd_rd:
    ds_read_b32 v12, v4 offset:0
    ds_read_b32 v14, v4 offset:256
    v_xor_b32 v20, 16, v5
    v_xor_b32 v21, 64, v5
    v_xor_b32 v22, 80, v5
    s_waitcnt vmcnt(4) lgkmcnt(0)
    v_mfma_f32_32x32x16_bf16 v[128:143], v[64:67], v[32:35], 0
    v_mfma_f32_32x32x16_bf16 v[128:143], v[68:71], v[36:39], v[128:143]
    v_mfma_f32_32x32x16_bf16 v[128:143], v[72:75], v[40:43], v[128:143]
    v_mfma_f32_32x32x16_bf16 v[128:143], v[76:79], v[44:47], v[128:143]
    s_waitcnt vmcnt(0)
    v_mfma_f32_32x32x16_bf16 v[144:159], v[80:83], v[32:35], 0
    v_mfma_f32_32x32x16_bf16 v[144:159], v[84:87], v[36:39], v[144:159]
    v_mfma_f32_32x32x16_bf16 v[144:159], v[88:91], v[40:43], v[144:159]
    v_mfma_f32_32x32x16_bf16 v[144:159], v[92:95], v[44:47], v[144:159]
    s_nop 6
    v_pk_mul_f32 v[128:129], v[128:129], v[12:13] op_sel_hi:[1,0]
    v_pk_mul_f32 v[130:131], v[130:131], v[12:13] op_sel_hi:[1,0]
    v_pk_mul_f32 v[132:133], v[132:133], v[12:13] op_sel_hi:[1,0]
    v_pk_mul_f32 v[134:135], v[134:135], v[12:13] op_sel_hi:[1,0]
    v_pk_mul_f32 v[136:137], v[136:137], v[12:13] op_sel_hi:[1,0]
    v_pk_mul_f32 v[138:139], v[138:139], v[12:13] op_sel_hi:[1,0]
    v_pk_mul_f32 v[140:141], v[140:141], v[12:13] op_sel_hi:[1,0]
    v_pk_mul_f32 v[142:143], v[142:143], v[12:13] op_sel_hi:[1,0]
    v_cvt_pk_bf16_f32 v96, v128, v129
    v_cvt_pk_bf16_f32 v97, v130, v131
    v_cvt_pk_bf16_f32 v98, v132, v133
    v_cvt_pk_bf16_f32 v99, v134, v135
    v_cvt_pk_bf16_f32 v100, v136, v137
    v_cvt_pk_bf16_f32 v101, v138, v139
    v_cvt_pk_bf16_f32 v102, v140, v141
    v_cvt_pk_bf16_f32 v103, v142, v143
    ds_write_b128 v5, v[96:99] offset:0
    ds_write_b128 v20, v[100:103] offset:0
    v_pk_mul_f32 v[144:145], v[144:145], v[12:13] op_sel_hi:[1,0]
    v_pk_mul_f32 v[146:147], v[146:147], v[12:13] op_sel_hi:[1,0]
    v_pk_mul_f32 v[148:149], v[148:149], v[12:13] op_sel_hi:[1,0]
    v_pk_mul_f32 v[150:151], v[150:151], v[12:13] op_sel_hi:[1,0]
    v_pk_mul_f32 v[152:153], v[152:153], v[12:13] op_sel_hi:[1,0]
    v_pk_mul_f32 v[154:155], v[154:155], v[12:13] op_sel_hi:[1,0]
    v_pk_mul_f32 v[156:157], v[156:157], v[12:13] op_sel_hi:[1,0]
    v_pk_mul_f32 v[158:159], v[158:159], v[12:13] op_sel_hi:[1,0]
    v_cvt_pk_bf16_f32 v104, v144, v145
    v_cvt_pk_bf16_f32 v105, v146, v147
    v_cvt_pk_bf16_f32 v106, v148, v149
    v_cvt_pk_bf16_f32 v107, v150, v151
    v_cvt_pk_bf16_f32 v108, v152, v153
    v_cvt_pk_bf16_f32 v109, v154, v155
    v_cvt_pk_bf16_f32 v110, v156, v157
    v_cvt_pk_bf16_f32 v111, v158, v159
    ds_write_b128 v21, v[104:107] offset:0
    ds_write_b128 v22, v[108:111] offset:0
    v_mfma_f32_32x32x16_bf16 v[160:175], v[64:67], v[48:51], 0
    v_mfma_f32_32x32x16_bf16 v[160:175], v[68:71], v[52:55], v[160:175]
    v_mfma_f32_32x32x16_bf16 v[160:175], v[72:75], v[56:59], v[160:175]
    v_mfma_f32_32x32x16_bf16 v[160:175], v[76:79], v[60:63], v[160:175]
    v_mfma_f32_32x32x16_bf16 v[176:191], v[80:83], v[48:51], 0
    v_mfma_f32_32x32x16_bf16 v[176:191], v[84:87], v[52:55], v[176:191]
    v_mfma_f32_32x32x16_bf16 v[176:191], v[88:91], v[56:59], v[176:191]
    v_mfma_f32_32x32x16_bf16 v[176:191], v[92:95], v[60:63], v[176:191]
    s_waitcnt lgkmcnt(0)
    ds_read_b128 v[192:195], v6 offset:0
    ds_read_b128 v[196:199], v6 offset:1024
    ds_read_b128 v[200:203], v6 offset:2048
    ds_read_b128 v[204:207], v6 offset:3072
    s_mov_b32 s71, 0
    s_waitcnt lgkmcnt(3)
    buffer_store_dwordx4 v[192:195], v7, s[36:39], s71 offen nt
    s_mov_b32 s71, 4096
    s_waitcnt lgkmcnt(2)
    buffer_store_dwordx4 v[196:199], v7, s[36:39], s71 offen nt
    s_mov_b32 s71, 8192
    s_waitcnt lgkmcnt(1)
    buffer_store_dwordx4 v[200:203], v7, s[36:39], s71 offen nt
    s_mov_b32 s71, 12288
    s_waitcnt lgkmcnt(0)
    buffer_store_dwordx4 v[204:207], v7, s[36:39], s71 offen nt
    v_pk_mul_f32 v[160:161], v[160:161], v[14:15] op_sel_hi:[1,0]
    v_pk_mul_f32 v[162:163], v[162:163], v[14:15] op_sel_hi:[1,0]
    v_pk_mul_f32 v[164:165], v[164:165], v[14:15] op_sel_hi:[1,0]
    v_pk_mul_f32 v[166:167], v[166:167], v[14:15] op_sel_hi:[1,0]
    v_pk_mul_f32 v[168:169], v[168:169], v[14:15] op_sel_hi:[1,0]
    v_pk_mul_f32 v[170:171], v[170:171], v[14:15] op_sel_hi:[1,0]
    v_pk_mul_f32 v[172:173], v[172:173], v[14:15] op_sel_hi:[1,0]
    v_pk_mul_f32 v[174:175], v[174:175], v[14:15] op_sel_hi:[1,0]
    v_cvt_pk_bf16_f32 v112, v160, v161
    v_cvt_pk_bf16_f32 v113, v162, v163
    v_cvt_pk_bf16_f32 v114, v164, v165
    v_cvt_pk_bf16_f32 v115, v166, v167
    v_cvt_pk_bf16_f32 v116, v168, v169
    v_cvt_pk_bf16_f32 v117, v170, v171
    v_cvt_pk_bf16_f32 v118, v172, v173
    v_cvt_pk_bf16_f32 v119, v174, v175
    ds_write_b128 v5, v[112:115] offset:4096
    ds_write_b128 v20, v[116:119] offset:4096
    v_pk_mul_f32 v[176:177], v[176:177], v[14:15] op_sel_hi:[1,0]
    v_pk_mul_f32 v[178:179], v[178:179], v[14:15] op_sel_hi:[1,0]
    v_pk_mul_f32 v[180:181], v[180:181], v[14:15] op_sel_hi:[1,0]
    v_pk_mul_f32 v[182:183], v[182:183], v[14:15] op_sel_hi:[1,0]
    v_pk_mul_f32 v[184:185], v[184:185], v[14:15] op_sel_hi:[1,0]
    v_pk_mul_f32 v[186:187], v[186:187], v[14:15] op_sel_hi:[1,0]
    v_pk_mul_f32 v[188:189], v[188:189], v[14:15] op_sel_hi:[1,0]
    v_pk_mul_f32 v[190:191], v[190:191], v[14:15] op_sel_hi:[1,0]
    v_cvt_pk_bf16_f32 v120, v176, v177
    v_cvt_pk_bf16_f32 v121, v178, v179
    v_cvt_pk_bf16_f32 v122, v180, v181
    v_cvt_pk_bf16_f32 v123, v182, v183
    v_cvt_pk_bf16_f32 v124, v184, v185
    v_cvt_pk_bf16_f32 v125, v186, v187
    v_cvt_pk_bf16_f32 v126, v188, v189
    v_cvt_pk_bf16_f32 v127, v190, v191
    ds_write_b128 v21, v[120:123] offset:4096
    ds_write_b128 v22, v[124:127] offset:4096
    s_waitcnt lgkmcnt(0)
    ds_read_b128 v[208:211], v6 offset:4096
    ds_read_b128 v[212:215], v6 offset:5120
    ds_read_b128 v[216:219], v6 offset:6144
    ds_read_b128 v[220:223], v6 offset:7168
    s_mov_b32 s71, 16384
    s_waitcnt lgkmcnt(3)
    buffer_store_dwordx4 v[208:211], v7, s[36:39], s71 offen nt
    s_mov_b32 s71, 20480
    s_waitcnt lgkmcnt(2)
    buffer_store_dwordx4 v[212:215], v7, s[36:39], s71 offen nt
    s_mov_b32 s71, 24576
    s_waitcnt lgkmcnt(1)
    buffer_store_dwordx4 v[216:219], v7, s[36:39], s71 offen nt
    s_mov_b32 s71, 28672
    s_waitcnt lgkmcnt(0)
    buffer_store_dwordx4 v[220:223], v7, s[36:39], s71 offen nt
    s_nop 1
L_end:
    s_endpgm

.section .rodata,"a"
.p2align 6
.amdhsa_kernel standalone__linear_kernel_rfa__prompt_kernel
  .amdhsa_next_free_vgpr 256
  .amdhsa_next_free_sgpr 102
  .amdhsa_accum_offset 256
  .amdhsa_group_segment_fixed_size 0
  .amdhsa_kernarg_size 56
  .amdhsa_user_sgpr_count 2
  .amdhsa_user_sgpr_kernarg_segment_ptr 1
  .amdhsa_system_sgpr_workgroup_id_x 1
  .amdhsa_float_denorm_mode_32 3
.end_amdhsa_kernel
```
